```python
import torch

def _softmax(x, axis=-1):
    return torch.softmax(x, dim=axis)
def _gelu(x):
    return torch.nn.functional.gelu(x, approximate="tanh")
def _silu(x):
    return torch.nn.functional.silu(x)
def _sigmoid(x):
    return torch.sigmoid(x)
def _layernorm(x, axis=-1, eps=1e-5):
    m = x.mean(dim=axis, keepdim=True)
    v = x.var(dim=axis, keepdim=True, unbiased=False)
    return (x - m) / torch.sqrt(v + eps)
def _scatter_add(tgt, idx, src, axis=0):
    return tgt.clone().index_add_(axis, idx, src)
def _segment_sum(src, seg, n):
    out = torch.zeros((n,) + src.shape[1:], dtype=src.dtype)
    return out.index_add_(0, seg, src)
def _pad(x, pw):
    flat = tuple(v for pair in reversed(pw) for v in pair)
    return torch.nn.functional.pad(x, flat)

kernel_name = 'recurrent_scan__gqa_block_cached__glu_gated_bilinear__decode'

def setup_inputs():

    _w = (lambda a: (lambda t: t.to(torch.bfloat16) if t.is_floating_point() else t)(torch.as_tensor(a)))
    def _A_setup():
        B, Sq, D = 8, 1, 448
        Hq, Hkv, Sk, Dh = 16, 8, 8192, 256
        assert Hq % Hkv == 0, (Hq, Hkv)
        return {
            "x": _w((lambda *s: torch.randn(*s, dtype=torch.bfloat16) * 0.4)(B, Sq, D)),
            "k_cache": _w((lambda *s: torch.randn(*s, dtype=torch.bfloat16) * 1.6)(B, Hkv, Sk, Dh)),
            "v_cache": _w((lambda *s: torch.randn(*s, dtype=torch.bfloat16) * 1.6)(B, Hkv, Sk, Dh)),
            "wq": _w((lambda *s: torch.randn(*s, dtype=torch.bfloat16) * 1.6)(D, Hq * Dh) * (D ** -0.5)),
            "wo": _w((lambda *s: torch.randn(*s, dtype=torch.bfloat16) * 1.6)(Hq * Dh, D) * ((Hq * Dh) ** -0.5)),
        }
    _A_in = _A_setup()

    def _B_setup():
        B, S, D, F = 8, 1, 448, 1792
        return {
            "x": _w((lambda *s: torch.randn(*s, dtype=torch.bfloat16) * 0.4)(B, S, D)),
            "w_gate": _w((lambda *s: torch.randn(*s, dtype=torch.bfloat16) * 1.6)(D, F) * (D ** -0.5)),
            "w_up": _w((lambda *s: torch.randn(*s, dtype=torch.bfloat16) * 1.6)(D, F) * (D ** -0.5)),
            "w_down": _w((lambda *s: torch.randn(*s, dtype=torch.bfloat16) * 1.6)(F, D) * (F ** -0.5)),
        }
    _B_in = _B_setup()

    return {
        "A_x": _A_in["x"],
        "A_k_cache": _A_in["k_cache"],
        "A_v_cache": _A_in["v_cache"],
        "A_wq": _A_in["wq"],
        "A_wo": _A_in["wo"],
        "B_x": _B_in["x"],
        "B_w_gate": _B_in["w_gate"],
        "B_w_up": _B_in["w_up"],
        "B_w_down": _B_in["w_down"],
    }

def reference(A_x, A_k_cache, A_v_cache, A_wq, A_wo, B_x, B_w_gate, B_w_up, B_w_down):
    def _A_ref(x, k_cache, v_cache, wq, wo):
        B, Sq, D = x.shape
        Hq, Dh = 16, 256
        Hkv = k_cache.shape[1]
        rep = Hq // Hkv
        q = (lambda x, *d: x.permute(*d))((x @ wq).reshape(B, Sq, Hq, Dh), 0, 2, 1, 3)
        k = (lambda x, n, axis: torch.repeat_interleave(x, n, dim=axis))(k_cache, rep, axis=1)
        v = (lambda x, n, axis: torch.repeat_interleave(x, n, dim=axis))(v_cache, rep, axis=1)
        scores = torch.einsum("bhqd,bhkd->bhqk", q, k) * (Dh ** -0.5)
        p = _softmax(scores, axis=-1)
        o = torch.einsum("bhqk,bhkd->bhqd", p, v)
        return (lambda x, *d: x.permute(*d))(o, 0, 2, 1, 3).reshape(B, Sq, Hq * Dh) @ wo

    def _B_ref(x, w_gate, w_up, w_down):
        g = torch.einsum("bsd,df->bsf", x, w_gate)
        u = torch.einsum("bsd,df->bsf", x, w_up)
        h = g * u
        return torch.einsum("bsf,fd->bsd", h, w_down)

    x = A_x
    xn = _layernorm(x, axis=-1)
    s = _A_ref(xn, A_k_cache, A_v_cache, A_wq, A_wo)
    g = _silu(_B_ref(xn, B_w_gate, B_w_up, B_w_down))
    return x + s * g
```

```asm
; @launch grid=(256,1,1) block=(512,1,1) lds=158016
.amdgcn_target "amdgcn-amd-amdhsa--gfx950"
.text
.globl recurrent_scan__gqa_block_cached__glu_gated_bilinear__decode_kernel
.p2align 8
.type recurrent_scan__gqa_block_cached__glu_gated_bilinear__decode_kernel,@function
recurrent_scan__gqa_block_cached__glu_gated_bilinear__decode_kernel:
    s_cmp_ge_u32 s2, 256
    s_cbranch_scc1 L_end
    s_load_dwordx16 s[4:19], s[0:1], 0
    s_load_dwordx8 s[20:27], s[0:1], 64
    v_lshrrev_b32 v1, 6, v0
    v_and_b32 v0, 63, v0
    s_and_b32 s72, s2, 7
    s_lshr_b32 s73, s2, 3
    v_readfirstlane_b32 s74, v1
    s_xor_b32 s74, s74, 4
    s_and_b32 s75, s73, 0
    s_xor_b32 s75, s75, 7
    s_and_b32 s75, s75, s72
    s_bcnt1_i32_b32 s75, s75
    s_and_b32 s75, s75, 1
    s_lshl_b32 s76, s73, 1
    s_or_b32 s75, s75, s76
    s_and_b32 s76, s72, 3
    s_bfe_u32 s77, s73, 0x20002
    s_cmp_eq_u32 s77, s76
    s_cselect_b32 s3, 1, 0
    s_xor_b32 s77, s77, 2
    s_and_b32 s78, s73, 1
    s_lshl_b32 s78, s78, 2
    s_or_b32 s77, s77, s78
    s_xor_b32 s78, s77, s72
    s_lshr_b32 s78, 0x14, s78
    s_and_b32 s3, s78, 1
    s_cmp_lt_u32 s73, 28
    s_cselect_b32 s78, 2, 0
    s_cmp_eq_u32 s72, s77
    s_cselect_b32 s3, s78, s3
    s_lshl_b32 s77, s75, 22
    s_lshl_b32 s97, s2, 8
    s_lshl_b32 s78, s74, 5
    s_add_u32 s97, s97, s78
    s_add_u32 s97, s97, 524288
    v_lshrrev_b32 v4, 5, v0
    v_and_b32 v5, 31, v0
    s_lshl_b32 s78, s75, 3
    s_add_u32 s78, s78, s76
    v_lshl_add_u32 v6, v4, 2, s78
    v_lshrrev_b32 v2, 4, v5
    v_lshl_add_u32 v2, v6, 1, v2
    v_mul_u32_u24 v2, 384, v2
    v_and_b32 v3, 15, v0
    v_lshl_add_u32 v2, v3, 4, v2
    v_add_u32 v2, 0, v2
    v_and_b32 v6, 15, v0
    v_lshrrev_b32 v7, 4, v0
    s_cmp_ge_u32 s74, 4
    s_cbranch_scc1 L_side
    v_add_u32 v46, 0, v4
    v_xor_b32 v46, v46, v5
    v_lshlrev_b32 v46, 4, v46
    v_lshl_add_u32 v8, v4, 9, v46
    v_add_u32 v46, 2, v4
    v_xor_b32 v46, v46, v5
    v_lshlrev_b32 v46, 4, v46
    v_lshl_add_u32 v9, v4, 9, v46
    v_add_u32 v46, 4, v4
    v_xor_b32 v46, v46, v5
    v_lshlrev_b32 v46, 4, v46
    v_lshl_add_u32 v10, v4, 9, v46
    v_add_u32 v46, 6, v4
    v_xor_b32 v46, v46, v5
    v_lshlrev_b32 v46, 4, v46
    v_lshl_add_u32 v11, v4, 9, v46
    v_add_u32 v46, 8, v4
    v_xor_b32 v46, v46, v5
    v_lshlrev_b32 v46, 4, v46
    v_lshl_add_u32 v12, v4, 9, v46
    v_add_u32 v46, 10, v4
    v_xor_b32 v46, v46, v5
    v_lshlrev_b32 v46, 4, v46
    v_lshl_add_u32 v13, v4, 9, v46
    v_add_u32 v46, 12, v4
    v_xor_b32 v46, v46, v5
    v_lshlrev_b32 v46, 4, v46
    v_lshl_add_u32 v14, v4, 9, v46
    v_add_u32 v46, 14, v4
    v_xor_b32 v46, v46, v5
    v_lshlrev_b32 v46, 4, v46
    v_lshl_add_u32 v15, v4, 9, v46
    v_add_u32 v46, 0, v4
    v_lshlrev_b32 v46, 1, v46
    v_xor_b32 v46, v46, v5
    v_lshlrev_b32 v46, 4, v46
    v_lshl_add_u32 v16, v4, 9, v46
    v_add_u32 v46, 2, v4
    v_lshlrev_b32 v46, 1, v46
    v_xor_b32 v46, v46, v5
    v_lshlrev_b32 v46, 4, v46
    v_lshl_add_u32 v17, v4, 9, v46
    v_add_u32 v46, 4, v4
    v_lshlrev_b32 v46, 1, v46
    v_xor_b32 v46, v46, v5
    v_lshlrev_b32 v46, 4, v46
    v_lshl_add_u32 v18, v4, 9, v46
    v_add_u32 v46, 6, v4
    v_lshlrev_b32 v46, 1, v46
    v_xor_b32 v46, v46, v5
    v_lshlrev_b32 v46, 4, v46
    v_lshl_add_u32 v19, v4, 9, v46
    s_lshl_b32 s79, s74, 15
    s_lshl_b32 s80, s76, 2
    s_add_u32 s80, s80, s74
    s_lshr_b32 s81, s80, 1
    s_mul_i32 s81, s81, 32768
    s_and_b32 s82, s80, 1
    s_mul_i32 s82, s82, 8192
    s_add_u32 s81, s81, s82
    s_mov_b32 s30, 0x400000
    s_mov_b32 s31, 0x20000
    s_mov_b32 s34, 0x400000
    s_mov_b32 s35, 0x20000
    s_waitcnt lgkmcnt(0)
    s_add_u32 s28, s6, s77
    s_addc_u32 s29, s7, 0
    s_add_u32 s32, s8, s77
    s_addc_u32 s33, s9, 0
    s_cmp_lg_u32 s3, 1
    s_cbranch_scc1 L_b1
    s_barrier
L_b1:
    s_waitcnt vmcnt(6)
    s_add_u32 s83, s81, 0
    s_add_u32 m0, s79, 0
    s_nop 0
    buffer_load_dwordx4 v8, s[28:31], s83 offen offset:0 nt lds
    buffer_load_dwordx4 v9, s[28:31], s83 offen offset:1024 nt lds
    s_waitcnt vmcnt(6)
    buffer_load_dwordx4 v10, s[28:31], s83 offen offset:2048 nt lds
    buffer_load_dwordx4 v11, s[28:31], s83 offen offset:3072 nt lds
    s_waitcnt vmcnt(6)
    s_add_u32 s83, s81, 4096
    s_add_u32 m0, s79, 4096
    s_nop 0
    buffer_load_dwordx4 v12, s[28:31], s83 offen offset:0 nt lds
    buffer_load_dwordx4 v13, s[28:31], s83 offen offset:1024 nt lds
    s_waitcnt vmcnt(6)
    buffer_load_dwordx4 v14, s[28:31], s83 offen offset:2048 nt lds
    buffer_load_dwordx4 v15, s[28:31], s83 offen offset:3072 nt lds
    s_cmp_eq_u32 s3, 1
    s_cbranch_scc1 L_b2
    s_barrier
L_b2:
    s_mov_b32 s68, s26
    s_mov_b32 s69, s27
    s_mov_b32 s70, 2097152
    s_mov_b32 s71, 0x20000
    v_add_u32 v46, 0, v7
    v_xor_b32 v46, v46, v6
    v_lshlrev_b32 v46, 4, v46
    v_lshl_add_u32 v46, v6, 9, v46
    v_add_u32 v20, s79, v46
    v_add_u32 v46, 4, v7
    v_xor_b32 v46, v46, v6
    v_lshlrev_b32 v46, 4, v46
    v_lshl_add_u32 v46, v6, 9, v46
    v_add_u32 v21, s79, v46
    v_add_u32 v46, 8, v7
    v_xor_b32 v46, v46, v6
    v_lshlrev_b32 v46, 4, v46
    v_lshl_add_u32 v46, v6, 9, v46
    v_add_u32 v22, s79, v46
    v_add_u32 v46, 12, v7
    v_xor_b32 v46, v46, v6
    v_lshlrev_b32 v46, 4, v46
    v_lshl_add_u32 v46, v6, 9, v46
    v_add_u32 v23, s79, v46
    v_lshrrev_b32 v46, 2, v6
    v_lshl_add_u32 v46, v7, 2, v46
    v_and_b32 v47, 7, v46
    v_and_b32 v48, 3, v0
    v_lshlrev_b32 v48, 3, v48
    v_lshl_add_u32 v48, v46, 9, v48
    v_add_u32 v48, s79, v48
    v_add_u32 v48, 16384, v48
    v_xor_b32 v46, 0, v47
    v_lshl_add_u32 v24, v46, 5, v48
    v_xor_b32 v46, 1, v47
    v_lshl_add_u32 v25, v46, 5, v48
    v_xor_b32 v46, 2, v47
    v_lshl_add_u32 v26, v46, 5, v48
    v_xor_b32 v46, 3, v47
    v_lshl_add_u32 v27, v46, 5, v48
    v_xor_b32 v46, 4, v47
    v_lshl_add_u32 v28, v46, 5, v48
    v_xor_b32 v46, 5, v47
    v_lshl_add_u32 v29, v46, 5, v48
    v_xor_b32 v46, 6, v47
    v_lshl_add_u32 v30, v46, 5, v48
    v_xor_b32 v46, 7, v47
    v_lshl_add_u32 v31, v46, 5, v48
    v_mov_b32 v44, 0xff7fffff
    v_mov_b32 v45, 0
    s_mov_b32 s84, 1035512379
    v_mov_b32 v62, 1
    s_lshl_b32 s85, s75, 8
    s_add_u32 s85, s85, 458752
    v_mov_b32 v61, s85
    s_mov_b32 s85, 0
    s_waitcnt vmcnt(6)
    s_add_u32 s83, s81, 16384
    s_add_u32 m0, s79, 8192
    s_nop 0
    buffer_load_dwordx4 v8, s[28:31], s83 offen offset:0 nt lds
    buffer_load_dwordx4 v9, s[28:31], s83 offen offset:1024 nt lds
    s_waitcnt vmcnt(6)
    buffer_load_dwordx4 v10, s[28:31], s83 offen offset:2048 nt lds
    buffer_load_dwordx4 v11, s[28:31], s83 offen offset:3072 nt lds
    s_waitcnt vmcnt(6)
    s_add_u32 s83, s81, 20480
    s_add_u32 m0, s79, 12288
    s_nop 0
    buffer_load_dwordx4 v12, s[28:31], s83 offen offset:0 nt lds
    buffer_load_dwordx4 v13, s[28:31], s83 offen offset:1024 nt lds
    s_waitcnt vmcnt(6)
    buffer_load_dwordx4 v14, s[28:31], s83 offen offset:2048 nt lds
    buffer_load_dwordx4 v15, s[28:31], s83 offen offset:3072 nt lds
    s_cmp_lg_u32 s3, 1
    s_cbranch_scc1 L_b3
    v_mov_b32 v47, 155864
    s_mov_b32 s96, 0
L_sp1:
    ds_read_b32 v46, v47
    s_waitcnt lgkmcnt(0)
    v_readfirstlane_b32 s95, v46
    s_cmp_ge_u32 s95, 4
    s_cbranch_scc1 L_sd2
    s_sleep 1
    s_add_u32 s96, s96, 1
    s_cmp_lt_u32 s96, 2097152
    s_cbranch_scc1 L_sp1
L_sd2:
L_b3:
    s_waitcnt vmcnt(6)
    s_add_u32 s83, s81, 0
    s_add_u32 m0, s79, 16384
    s_nop 0
    buffer_load_dwordx4 v16, s[32:35], s83 offen offset:0 nt lds
    buffer_load_dwordx4 v17, s[32:35], s83 offen offset:1024 nt lds
    s_waitcnt vmcnt(6)
    buffer_load_dwordx4 v18, s[32:35], s83 offen offset:2048 nt lds
    buffer_load_dwordx4 v19, s[32:35], s83 offen offset:3072 nt lds
    s_waitcnt vmcnt(6)
    s_add_u32 s83, s81, 4096
    s_add_u32 m0, s79, 20480
    s_nop 0
    buffer_load_dwordx4 v16, s[32:35], s83 offen offset:0 nt lds
    buffer_load_dwordx4 v17, s[32:35], s83 offen offset:1024 nt lds
    s_waitcnt vmcnt(6)
    buffer_load_dwordx4 v18, s[32:35], s83 offen offset:2048 nt lds
    buffer_load_dwordx4 v19, s[32:35], s83 offen offset:3072 nt lds
    s_waitcnt vmcnt(6)
    s_add_u32 s83, s81, 16384
    s_add_u32 m0, s79, 24576
    s_nop 0
    buffer_load_dwordx4 v16, s[32:35], s83 offen offset:0 nt lds
    buffer_load_dwordx4 v17, s[32:35], s83 offen offset:1024 nt lds
    s_waitcnt vmcnt(6)
    buffer_load_dwordx4 v18, s[32:35], s83 offen offset:2048 nt lds
    buffer_load_dwordx4 v19, s[32:35], s83 offen offset:3072 nt lds
    s_waitcnt vmcnt(6)
    s_add_u32 s83, s81, 20480
    s_add_u32 m0, s79, 28672
    s_nop 0
    buffer_load_dwordx4 v16, s[32:35], s83 offen offset:0 nt lds
    buffer_load_dwordx4 v17, s[32:35], s83 offen offset:1024 nt lds
    s_waitcnt vmcnt(6)
    buffer_load_dwordx4 v18, s[32:35], s83 offen offset:2048 nt lds
    buffer_load_dwordx4 v19, s[32:35], s83 offen offset:3072 nt lds
    v_mov_b32 v47, 155884
    v_mov_b32 v46, 1
    ds_write_b32 v47, v46
    s_add_u32 s80, s80, 16
    s_waitcnt vmcnt(16)
    ds_read_b128 v[128:131], v20 offset:0
    ds_read_b128 v[132:135], v21 offset:0
    ds_read_b128 v[136:139], v22 offset:0
    ds_read_b128 v[140:143], v23 offset:0
    ds_read_b128 v[144:147], v20 offset:256
    ds_read_b128 v[148:151], v21 offset:256
    ds_read_b128 v[152:155], v22 offset:256
    ds_read_b128 v[156:159], v23 offset:256
    ds_read_b128 v[160:163], v20 offset:8192
    ds_read_b128 v[164:167], v21 offset:8192
    ds_read_b128 v[168:171], v22 offset:8192
    ds_read_b128 v[172:175], v23 offset:8192
    ds_read_b128 v[176:179], v20 offset:8448
    ds_read_b128 v[180:183], v21 offset:8448
    ds_read_b128 v[184:187], v22 offset:8448
    ds_read_b128 v[188:191], v23 offset:8448
    s_lshr_b32 s81, s80, 1
    s_mul_i32 s81, s81, 32768
    s_and_b32 s82, s80, 1
    s_mul_i32 s82, s82, 8192
    s_add_u32 s81, s81, s82
    s_waitcnt lgkmcnt(0)
    s_waitcnt vmcnt(6)
    s_add_u32 s83, s81, 0
    s_add_u32 m0, s79, 0
    s_nop 0
    buffer_load_dwordx4 v8, s[28:31], s83 offen offset:0 nt lds
    buffer_load_dwordx4 v9, s[28:31], s83 offen offset:1024 nt lds
    s_waitcnt vmcnt(6)
    buffer_load_dwordx4 v10, s[28:31], s83 offen offset:2048 nt lds
    buffer_load_dwordx4 v11, s[28:31], s83 offen offset:3072 nt lds
    s_waitcnt vmcnt(6)
    s_add_u32 s83, s81, 4096
    s_add_u32 m0, s79, 4096
    s_nop 0
    buffer_load_dwordx4 v12, s[28:31], s83 offen offset:0 nt lds
    buffer_load_dwordx4 v13, s[28:31], s83 offen offset:1024 nt lds
    s_waitcnt vmcnt(6)
    buffer_load_dwordx4 v14, s[28:31], s83 offen offset:2048 nt lds
    buffer_load_dwordx4 v15, s[28:31], s83 offen offset:3072 nt lds
    s_waitcnt vmcnt(6)
    s_add_u32 s83, s81, 16384
    s_add_u32 m0, s79, 8192
    s_nop 0
    buffer_load_dwordx4 v8, s[28:31], s83 offen offset:0 nt lds
    buffer_load_dwordx4 v9, s[28:31], s83 offen offset:1024 nt lds
    s_waitcnt vmcnt(6)
    buffer_load_dwordx4 v10, s[28:31], s83 offen offset:2048 nt lds
    buffer_load_dwordx4 v11, s[28:31], s83 offen offset:3072 nt lds
    s_waitcnt vmcnt(6)
    s_add_u32 s83, s81, 20480
    s_add_u32 m0, s79, 12288
    s_nop 0
    buffer_load_dwordx4 v12, s[28:31], s83 offen offset:0 nt lds
    buffer_load_dwordx4 v13, s[28:31], s83 offen offset:1024 nt lds
    s_waitcnt vmcnt(6)
    buffer_load_dwordx4 v14, s[28:31], s83 offen offset:2048 nt lds
    buffer_load_dwordx4 v15, s[28:31], s83 offen offset:3072 nt lds
    s_waitcnt vmcnt(16)
    ds_read_b64_tr_b16 v[68:69], v24 offset:0
    ds_read_b64_tr_b16 v[70:71], v24 offset:8192
    ds_read_b64_tr_b16 v[72:73], v25 offset:0
    ds_read_b64_tr_b16 v[74:75], v25 offset:8192
    ds_read_b64_tr_b16 v[76:77], v26 offset:0
    ds_read_b64_tr_b16 v[78:79], v26 offset:8192
    ds_read_b64_tr_b16 v[80:81], v27 offset:0
    ds_read_b64_tr_b16 v[82:83], v27 offset:8192
    ds_read_b64_tr_b16 v[84:85], v28 offset:0
    ds_read_b64_tr_b16 v[86:87], v28 offset:8192
    ds_read_b64_tr_b16 v[88:89], v29 offset:0
    ds_read_b64_tr_b16 v[90:91], v29 offset:8192
    ds_read_b64_tr_b16 v[92:93], v30 offset:0
    ds_read_b64_tr_b16 v[94:95], v30 offset:8192
    ds_read_b64_tr_b16 v[96:97], v31 offset:0
    ds_read_b64_tr_b16 v[98:99], v31 offset:8192
    ds_read_b64_tr_b16 v[100:101], v24 offset:256
    ds_read_b64_tr_b16 v[102:103], v24 offset:8448
    ds_read_b64_tr_b16 v[104:105], v25 offset:256
    ds_read_b64_tr_b16 v[106:107], v25 offset:8448
    ds_read_b64_tr_b16 v[108:109], v26 offset:256
    ds_read_b64_tr_b16 v[110:111], v26 offset:8448
    ds_read_b64_tr_b16 v[112:113], v27 offset:256
    ds_read_b64_tr_b16 v[114:115], v27 offset:8448
    ds_read_b64_tr_b16 v[116:117], v28 offset:256
    ds_read_b64_tr_b16 v[118:119], v28 offset:8448
    ds_read_b64_tr_b16 v[120:121], v29 offset:256
    ds_read_b64_tr_b16 v[122:123], v29 offset:8448
    ds_read_b64_tr_b16 v[124:125], v30 offset:256
    ds_read_b64_tr_b16 v[126:127], v30 offset:8448
    ds_read_b64_tr_b16 v[224:225], v31 offset:256
    ds_read_b64_tr_b16 v[226:227], v31 offset:8448
    s_waitcnt lgkmcnt(0)
    s_waitcnt vmcnt(6)
    s_add_u32 s83, s81, 0
    s_add_u32 m0, s79, 16384
    s_nop 0
    buffer_load_dwordx4 v16, s[32:35], s83 offen offset:0 nt lds
    buffer_load_dwordx4 v17, s[32:35], s83 offen offset:1024 nt lds
    s_waitcnt vmcnt(6)
    buffer_load_dwordx4 v18, s[32:35], s83 offen offset:2048 nt lds
    buffer_load_dwordx4 v19, s[32:35], s83 offen offset:3072 nt lds
    s_waitcnt vmcnt(6)
    s_add_u32 s83, s81, 4096
    s_add_u32 m0, s79, 20480
    s_nop 0
    buffer_load_dwordx4 v16, s[32:35], s83 offen offset:0 nt lds
    buffer_load_dwordx4 v17, s[32:35], s83 offen offset:1024 nt lds
    s_waitcnt vmcnt(6)
    buffer_load_dwordx4 v18, s[32:35], s83 offen offset:2048 nt lds
    buffer_load_dwordx4 v19, s[32:35], s83 offen offset:3072 nt lds
    s_waitcnt vmcnt(6)
    s_add_u32 s83, s81, 16384
    s_add_u32 m0, s79, 24576
    s_nop 0
    buffer_load_dwordx4 v16, s[32:35], s83 offen offset:0 nt lds
    buffer_load_dwordx4 v17, s[32:35], s83 offen offset:1024 nt lds
    s_waitcnt vmcnt(6)
    buffer_load_dwordx4 v18, s[32:35], s83 offen offset:2048 nt lds
    buffer_load_dwordx4 v19, s[32:35], s83 offen offset:3072 nt lds
    s_waitcnt vmcnt(6)
    s_add_u32 s83, s81, 20480
    s_add_u32 m0, s79, 28672
    s_nop 0
    buffer_load_dwordx4 v16, s[32:35], s83 offen offset:0 nt lds
    buffer_load_dwordx4 v17, s[32:35], s83 offen offset:1024 nt lds
    s_waitcnt vmcnt(6)
    buffer_load_dwordx4 v18, s[32:35], s83 offen offset:2048 nt lds
    buffer_load_dwordx4 v19, s[32:35], s83 offen offset:3072 nt lds
    v_mov_b32 v47, 155840
    s_mov_b32 s96, 0
L_sp3:
    ds_read_b32 v46, v47
    s_waitcnt lgkmcnt(0)
    v_readfirstlane_b32 s95, v46
    s_cmp_ge_u32 s95, 1
    s_cbranch_scc1 L_sd4
    s_sleep 1
    s_add_u32 s96, s96, 1
    s_cmp_lt_u32 s96, 2097152
    s_cbranch_scc1 L_sp3
L_sd4:
L_qok:
    v_and_b32 v46, 1, v0
    v_mul_u32_u24 v46, 528, v46
    v_lshl_add_u32 v46, v7, 4, v46
    v_add_u32 v46, 154752, v46
    ds_read_b128 v[192:195], v46 offset:0
    ds_read_b128 v[196:199], v46 offset:64
    ds_read_b128 v[200:203], v46 offset:128
    ds_read_b128 v[204:207], v46 offset:192
    ds_read_b128 v[208:211], v46 offset:256
    ds_read_b128 v[212:215], v46 offset:320
    ds_read_b128 v[216:219], v46 offset:384
    ds_read_b128 v[220:223], v46 offset:448
    s_waitcnt lgkmcnt(0)
    v_mfma_f32_16x16x32_bf16 v[32:35], v[128:131], v[192:195], 0
    v_mfma_f32_16x16x32_bf16 v[36:39], v[160:163], v[192:195], 0
    v_mfma_f32_16x16x32_bf16 v[32:35], v[132:135], v[196:199], v[32:35]
    v_mfma_f32_16x16x32_bf16 v[36:39], v[164:167], v[196:199], v[36:39]
    v_mfma_f32_16x16x32_bf16 v[32:35], v[136:139], v[200:203], v[32:35]
    v_mfma_f32_16x16x32_bf16 v[36:39], v[168:171], v[200:203], v[36:39]
    v_mfma_f32_16x16x32_bf16 v[32:35], v[140:143], v[204:207], v[32:35]
    v_mfma_f32_16x16x32_bf16 v[36:39], v[172:175], v[204:207], v[36:39]
    v_mfma_f32_16x16x32_bf16 v[32:35], v[144:147], v[208:211], v[32:35]
    v_mfma_f32_16x16x32_bf16 v[36:39], v[176:179], v[208:211], v[36:39]
    v_mfma_f32_16x16x32_bf16 v[32:35], v[148:151], v[212:215], v[32:35]
    v_mfma_f32_16x16x32_bf16 v[36:39], v[180:183], v[212:215], v[36:39]
    v_mfma_f32_16x16x32_bf16 v[32:35], v[152:155], v[216:219], v[32:35]
    v_mfma_f32_16x16x32_bf16 v[36:39], v[184:187], v[216:219], v[36:39]
    v_mfma_f32_16x16x32_bf16 v[32:35], v[156:159], v[220:223], v[32:35]
    v_mfma_f32_16x16x32_bf16 v[36:39], v[188:191], v[220:223], v[36:39]
    s_nop 7
    v_cvt_pk_bf16_f32 v40, v32, v33
    v_cvt_pk_bf16_f32 v41, v34, v35
    v_cvt_pk_bf16_f32 v42, v36, v37
    v_cvt_pk_bf16_f32 v43, v38, v39
    v_lshlrev_b32 v32, 16, v40
    v_and_b32 v33, 0xffff0000, v40
    v_lshlrev_b32 v34, 16, v41
    v_and_b32 v35, 0xffff0000, v41
    v_lshlrev_b32 v36, 16, v42
    v_and_b32 v37, 0xffff0000, v42
    v_lshlrev_b32 v38, 16, v43
    v_and_b32 v39, 0xffff0000, v43
    v_max3_f32 v46, v32, v33, v34
    v_max3_f32 v47, v35, v36, v37
    v_max3_f32 v46, v46, v38, v39
    v_max_f32 v46, v46, v47
    v_mov_b32 v47, v46
    s_nop 1
    v_permlane32_swap_b32 v46, v47
    s_nop 1
    v_max_f32 v46, v46, v47
    v_mov_b32 v47, v46
    s_nop 1
    v_permlane16_swap_b32 v46, v47
    s_nop 1
    v_max_f32 v46, v46, v47
    v_mul_f32 v44, s84, v46
    v_fma_f32 v32, v32, s84, -v44
    v_fma_f32 v33, v33, s84, -v44
    v_fma_f32 v34, v34, s84, -v44
    v_fma_f32 v35, v35, s84, -v44
    v_fma_f32 v36, v36, s84, -v44
    v_fma_f32 v37, v37, s84, -v44
    v_fma_f32 v38, v38, s84, -v44
    v_fma_f32 v39, v39, s84, -v44
    v_exp_f32 v32, v32
    v_exp_f32 v33, v33
    v_exp_f32 v34, v34
    v_exp_f32 v35, v35
    v_exp_f32 v36, v36
    v_exp_f32 v37, v37
    v_exp_f32 v38, v38
    v_exp_f32 v39, v39
    v_add_f32 v46, v32, v33
    v_add_f32 v47, v34, v35
    v_add_f32 v48, v36, v37
    v_add_f32 v49, v38, v39
    v_cvt_pk_bf16_f32 v40, v32, v33
    v_cvt_pk_bf16_f32 v41, v34, v35
    v_cvt_pk_bf16_f32 v42, v36, v37
    v_cvt_pk_bf16_f32 v43, v38, v39
    v_add_f32 v46, v46, v47
    v_add_f32 v48, v48, v49
    v_add_f32 v45, v45, v46
    v_add_f32 v45, v45, v48
    v_mfma_f32_16x16x32_bf16 v[64:67], v[68:71], v[40:43], 0
    v_mfma_f32_16x16x32_bf16 v[68:71], v[72:75], v[40:43], 0
    v_mfma_f32_16x16x32_bf16 v[72:75], v[76:79], v[40:43], 0
    v_mfma_f32_16x16x32_bf16 v[76:79], v[80:83], v[40:43], 0
    v_mfma_f32_16x16x32_bf16 v[80:83], v[84:87], v[40:43], 0
    v_mfma_f32_16x16x32_bf16 v[84:87], v[88:91], v[40:43], 0
    v_mfma_f32_16x16x32_bf16 v[88:91], v[92:95], v[40:43], 0
    v_mfma_f32_16x16x32_bf16 v[92:95], v[96:99], v[40:43], 0
    v_mfma_f32_16x16x32_bf16 v[96:99], v[100:103], v[40:43], 0
    v_mfma_f32_16x16x32_bf16 v[100:103], v[104:107], v[40:43], 0
    v_mfma_f32_16x16x32_bf16 v[104:107], v[108:111], v[40:43], 0
    v_mfma_f32_16x16x32_bf16 v[108:111], v[112:115], v[40:43], 0
    v_mfma_f32_16x16x32_bf16 v[112:115], v[116:119], v[40:43], 0
    v_mfma_f32_16x16x32_bf16 v[116:119], v[120:123], v[40:43], 0
    v_mfma_f32_16x16x32_bf16 v[120:123], v[124:127], v[40:43], 0
    v_mfma_f32_16x16x32_bf16 v[124:127], v[224:227], v[40:43], 0
    s_add_u32 s80, s80, 16
    s_mov_b32 s85, 1
L_loop:
    s_waitcnt vmcnt(16)
    ds_read_b128 v[128:131], v20 offset:0
    ds_read_b128 v[132:135], v21 offset:0
    ds_read_b128 v[136:139], v22 offset:0
    ds_read_b128 v[140:143], v23 offset:0
    ds_read_b128 v[144:147], v20 offset:256
    ds_read_b128 v[148:151], v21 offset:256
    ds_read_b128 v[152:155], v22 offset:256
    ds_read_b128 v[156:159], v23 offset:256
    ds_read_b128 v[160:163], v20 offset:8192
    ds_read_b128 v[164:167], v21 offset:8192
    ds_read_b128 v[168:171], v22 offset:8192
    ds_read_b128 v[172:175], v23 offset:8192
    ds_read_b128 v[176:179], v20 offset:8448
    ds_read_b128 v[180:183], v21 offset:8448
    ds_read_b128 v[184:187], v22 offset:8448
    ds_read_b128 v[188:191], v23 offset:8448
    s_lshr_b32 s81, s80, 1
    s_mul_i32 s81, s81, 32768
    s_and_b32 s82, s80, 1
    s_mul_i32 s82, s82, 8192
    s_add_u32 s81, s81, s82
    s_waitcnt lgkmcnt(0)
    s_waitcnt vmcnt(10)
    s_add_u32 s83, s81, 0
    s_add_u32 m0, s79, 0
    s_nop 0
    buffer_load_dwordx4 v8, s[28:31], s83 offen offset:0 nt lds
    buffer_load_dwordx4 v9, s[28:31], s83 offen offset:1024 nt lds
    s_waitcnt vmcnt(10)
    buffer_load_dwordx4 v10, s[28:31], s83 offen offset:2048 nt lds
    buffer_load_dwordx4 v11, s[28:31], s83 offen offset:3072 nt lds
    s_waitcnt vmcnt(10)
    s_add_u32 s83, s81, 4096
    s_add_u32 m0, s79, 4096
    s_nop 0
    buffer_load_dwordx4 v12, s[28:31], s83 offen offset:0 nt lds
    buffer_load_dwordx4 v13, s[28:31], s83 offen offset:1024 nt lds
    s_waitcnt vmcnt(10)
    buffer_load_dwordx4 v14, s[28:31], s83 offen offset:2048 nt lds
    buffer_load_dwordx4 v15, s[28:31], s83 offen offset:3072 nt lds
    s_waitcnt vmcnt(10)
    s_add_u32 s83, s81, 16384
    s_add_u32 m0, s79, 8192
    s_nop 0
    buffer_load_dwordx4 v8, s[28:31], s83 offen offset:0 nt lds
    buffer_load_dwordx4 v9, s[28:31], s83 offen offset:1024 nt lds
    s_waitcnt vmcnt(10)
    buffer_load_dwordx4 v10, s[28:31], s83 offen offset:2048 nt lds
    buffer_load_dwordx4 v11, s[28:31], s83 offen offset:3072 nt lds
    s_waitcnt vmcnt(10)
    s_add_u32 s83, s81, 20480
    s_add_u32 m0, s79, 12288
    s_nop 0
    buffer_load_dwordx4 v12, s[28:31], s83 offen offset:0 nt lds
    buffer_load_dwordx4 v13, s[28:31], s83 offen offset:1024 nt lds
    s_waitcnt vmcnt(10)
    buffer_load_dwordx4 v14, s[28:31], s83 offen offset:2048 nt lds
    buffer_load_dwordx4 v15, s[28:31], s83 offen offset:3072 nt lds
    v_mfma_f32_16x16x32_bf16 v[32:35], v[128:131], v[192:195], 0
    v_mfma_f32_16x16x32_bf16 v[36:39], v[160:163], v[192:195], 0
    v_mfma_f32_16x16x32_bf16 v[32:35], v[132:135], v[196:199], v[32:35]
    v_mfma_f32_16x16x32_bf16 v[36:39], v[164:167], v[196:199], v[36:39]
    v_mfma_f32_16x16x32_bf16 v[32:35], v[136:139], v[200:203], v[32:35]
    v_mfma_f32_16x16x32_bf16 v[36:39], v[168:171], v[200:203], v[36:39]
    v_mfma_f32_16x16x32_bf16 v[32:35], v[140:143], v[204:207], v[32:35]
    v_mfma_f32_16x16x32_bf16 v[36:39], v[172:175], v[204:207], v[36:39]
    v_mfma_f32_16x16x32_bf16 v[32:35], v[144:147], v[208:211], v[32:35]
    v_mfma_f32_16x16x32_bf16 v[36:39], v[176:179], v[208:211], v[36:39]
    v_mfma_f32_16x16x32_bf16 v[32:35], v[148:151], v[212:215], v[32:35]
    v_mfma_f32_16x16x32_bf16 v[36:39], v[180:183], v[212:215], v[36:39]
    v_mfma_f32_16x16x32_bf16 v[32:35], v[152:155], v[216:219], v[32:35]
    v_mfma_f32_16x16x32_bf16 v[36:39], v[184:187], v[216:219], v[36:39]
    v_mfma_f32_16x16x32_bf16 v[32:35], v[156:159], v[220:223], v[32:35]
    v_mfma_f32_16x16x32_bf16 v[36:39], v[188:191], v[220:223], v[36:39]
    s_nop 7
    v_cvt_pk_bf16_f32 v40, v32, v33
    v_cvt_pk_bf16_f32 v41, v34, v35
    v_cvt_pk_bf16_f32 v42, v36, v37
    v_cvt_pk_bf16_f32 v43, v38, v39
    v_lshlrev_b32 v32, 16, v40
    v_and_b32 v33, 0xffff0000, v40
    v_lshlrev_b32 v34, 16, v41
    v_and_b32 v35, 0xffff0000, v41
    v_lshlrev_b32 v36, 16, v42
    v_and_b32 v37, 0xffff0000, v42
    v_lshlrev_b32 v38, 16, v43
    v_and_b32 v39, 0xffff0000, v43
    v_max3_f32 v46, v32, v33, v34
    v_max3_f32 v47, v35, v36, v37
    v_max3_f32 v46, v46, v38, v39
    v_max_f32 v46, v46, v47
    v_mov_b32 v47, v46
    s_nop 1
    v_permlane32_swap_b32 v46, v47
    s_nop 1
    v_max_f32 v46, v46, v47
    v_mov_b32 v47, v46
    s_nop 1
    v_permlane16_swap_b32 v46, v47
    s_nop 1
    v_max_f32 v46, v46, v47
    v_mul_f32 v46, s84, v46
    v_max_f32 v46, v46, v44
    v_sub_f32 v47, v44, v46
    v_cmp_neq_f32 vcc, v44, v46
    v_exp_f32 v48, v47
    v_mov_b32 v44, v46
    v_fma_f32 v32, v32, s84, -v44
    v_fma_f32 v33, v33, s84, -v44
    v_fma_f32 v34, v34, s84, -v44
    v_fma_f32 v35, v35, s84, -v44
    v_fma_f32 v36, v36, s84, -v44
    v_fma_f32 v37, v37, s84, -v44
    v_fma_f32 v38, v38, s84, -v44
    v_fma_f32 v39, v39, s84, -v44
    v_exp_f32 v32, v32
    v_exp_f32 v33, v33
    v_exp_f32 v34, v34
    v_exp_f32 v35, v35
    v_exp_f32 v36, v36
    v_exp_f32 v37, v37
    v_exp_f32 v38, v38
    v_exp_f32 v39, v39
    s_cbranch_vccz L_nr5
    v_mov_b32 v49, v48
    v_mul_f32 v45, v45, v48
    v_pk_mul_f32 v[64:65], v[64:65], v[48:49]
    v_pk_mul_f32 v[66:67], v[66:67], v[48:49]
    v_pk_mul_f32 v[68:69], v[68:69], v[48:49]
    v_pk_mul_f32 v[70:71], v[70:71], v[48:49]
    v_pk_mul_f32 v[72:73], v[72:73], v[48:49]
    v_pk_mul_f32 v[74:75], v[74:75], v[48:49]
    v_pk_mul_f32 v[76:77], v[76:77], v[48:49]
    v_pk_mul_f32 v[78:79], v[78:79], v[48:49]
    v_pk_mul_f32 v[80:81], v[80:81], v[48:49]
    v_pk_mul_f32 v[82:83], v[82:83], v[48:49]
    v_pk_mul_f32 v[84:85], v[84:85], v[48:49]
    v_pk_mul_f32 v[86:87], v[86:87], v[48:49]
    v_pk_mul_f32 v[88:89], v[88:89], v[48:49]
    v_pk_mul_f32 v[90:91], v[90:91], v[48:49]
    v_pk_mul_f32 v[92:93], v[92:93], v[48:49]
    v_pk_mul_f32 v[94:95], v[94:95], v[48:49]
    v_pk_mul_f32 v[96:97], v[96:97], v[48:49]
    v_pk_mul_f32 v[98:99], v[98:99], v[48:49]
    v_pk_mul_f32 v[100:101], v[100:101], v[48:49]
    v_pk_mul_f32 v[102:103], v[102:103], v[48:49]
    v_pk_mul_f32 v[104:105], v[104:105], v[48:49]
    v_pk_mul_f32 v[106:107], v[106:107], v[48:49]
    v_pk_mul_f32 v[108:109], v[108:109], v[48:49]
    v_pk_mul_f32 v[110:111], v[110:111], v[48:49]
    v_pk_mul_f32 v[112:113], v[112:113], v[48:49]
    v_pk_mul_f32 v[114:115], v[114:115], v[48:49]
    v_pk_mul_f32 v[116:117], v[116:117], v[48:49]
    v_pk_mul_f32 v[118:119], v[118:119], v[48:49]
    v_pk_mul_f32 v[120:121], v[120:121], v[48:49]
    v_pk_mul_f32 v[122:123], v[122:123], v[48:49]
    v_pk_mul_f32 v[124:125], v[124:125], v[48:49]
    v_pk_mul_f32 v[126:127], v[126:127], v[48:49]
L_nr5:
    v_add_f32 v46, v32, v33
    v_add_f32 v47, v34, v35
    v_add_f32 v48, v36, v37
    v_add_f32 v49, v38, v39
    v_cvt_pk_bf16_f32 v40, v32, v33
    v_cvt_pk_bf16_f32 v41, v34, v35
    v_cvt_pk_bf16_f32 v42, v36, v37
    v_cvt_pk_bf16_f32 v43, v38, v39
    v_add_f32 v46, v46, v47
    v_add_f32 v48, v48, v49
    v_add_f32 v45, v45, v46
    v_add_f32 v45, v45, v48
    s_waitcnt vmcnt(16)
    ds_read_b64_tr_b16 v[128:129], v24 offset:0
    ds_read_b64_tr_b16 v[130:131], v24 offset:8192
    ds_read_b64_tr_b16 v[132:133], v25 offset:0
    ds_read_b64_tr_b16 v[134:135], v25 offset:8192
    ds_read_b64_tr_b16 v[136:137], v26 offset:0
    ds_read_b64_tr_b16 v[138:139], v26 offset:8192
    ds_read_b64_tr_b16 v[140:141], v27 offset:0
    ds_read_b64_tr_b16 v[142:143], v27 offset:8192
    ds_read_b64_tr_b16 v[144:145], v28 offset:0
    ds_read_b64_tr_b16 v[146:147], v28 offset:8192
    ds_read_b64_tr_b16 v[148:149], v29 offset:0
    ds_read_b64_tr_b16 v[150:151], v29 offset:8192
    ds_read_b64_tr_b16 v[152:153], v30 offset:0
    ds_read_b64_tr_b16 v[154:155], v30 offset:8192
    ds_read_b64_tr_b16 v[156:157], v31 offset:0
    ds_read_b64_tr_b16 v[158:159], v31 offset:8192
    ds_read_b64_tr_b16 v[160:161], v24 offset:256
    ds_read_b64_tr_b16 v[162:163], v24 offset:8448
    ds_read_b64_tr_b16 v[164:165], v25 offset:256
    ds_read_b64_tr_b16 v[166:167], v25 offset:8448
    ds_read_b64_tr_b16 v[168:169], v26 offset:256
    ds_read_b64_tr_b16 v[170:171], v26 offset:8448
    ds_read_b64_tr_b16 v[172:173], v27 offset:256
    ds_read_b64_tr_b16 v[174:175], v27 offset:8448
    ds_read_b64_tr_b16 v[176:177], v28 offset:256
    ds_read_b64_tr_b16 v[178:179], v28 offset:8448
    ds_read_b64_tr_b16 v[180:181], v29 offset:256
    ds_read_b64_tr_b16 v[182:183], v29 offset:8448
    ds_read_b64_tr_b16 v[184:185], v30 offset:256
    ds_read_b64_tr_b16 v[186:187], v30 offset:8448
    ds_read_b64_tr_b16 v[188:189], v31 offset:256
    ds_read_b64_tr_b16 v[190:191], v31 offset:8448
    s_waitcnt lgkmcnt(0)
    s_waitcnt vmcnt(10)
    s_add_u32 s83, s81, 0
    s_add_u32 m0, s79, 16384
    s_nop 0
    buffer_load_dwordx4 v16, s[32:35], s83 offen offset:0 nt lds
    buffer_load_dwordx4 v17, s[32:35], s83 offen offset:1024 nt lds
    s_waitcnt vmcnt(10)
    buffer_load_dwordx4 v18, s[32:35], s83 offen offset:2048 nt lds
    buffer_load_dwordx4 v19, s[32:35], s83 offen offset:3072 nt lds
    s_waitcnt vmcnt(10)
    s_add_u32 s83, s81, 4096
    s_add_u32 m0, s79, 20480
    s_nop 0
    buffer_load_dwordx4 v16, s[32:35], s83 offen offset:0 nt lds
    buffer_load_dwordx4 v17, s[32:35], s83 offen offset:1024 nt lds
    s_waitcnt vmcnt(10)
    buffer_load_dwordx4 v18, s[32:35], s83 offen offset:2048 nt lds
    buffer_load_dwordx4 v19, s[32:35], s83 offen offset:3072 nt lds
    s_waitcnt vmcnt(10)
    s_add_u32 s83, s81, 16384
    s_add_u32 m0, s79, 24576
    s_nop 0
    buffer_load_dwordx4 v16, s[32:35], s83 offen offset:0 nt lds
    buffer_load_dwordx4 v17, s[32:35], s83 offen offset:1024 nt lds
    s_waitcnt vmcnt(10)
    buffer_load_dwordx4 v18, s[32:35], s83 offen offset:2048 nt lds
    buffer_load_dwordx4 v19, s[32:35], s83 offen offset:3072 nt lds
    s_waitcnt vmcnt(10)
    s_add_u32 s83, s81, 20480
    s_add_u32 m0, s79, 28672
    s_nop 0
    buffer_load_dwordx4 v16, s[32:35], s83 offen offset:0 nt lds
    buffer_load_dwordx4 v17, s[32:35], s83 offen offset:1024 nt lds
    s_waitcnt vmcnt(10)
    buffer_load_dwordx4 v18, s[32:35], s83 offen offset:2048 nt lds
    buffer_load_dwordx4 v19, s[32:35], s83 offen offset:3072 nt lds
    v_mfma_f32_16x16x32_bf16 v[64:67], v[128:131], v[40:43], v[64:67]
    v_mfma_f32_16x16x32_bf16 v[68:71], v[132:135], v[40:43], v[68:71]
    v_mfma_f32_16x16x32_bf16 v[72:75], v[136:139], v[40:43], v[72:75]
    v_mfma_f32_16x16x32_bf16 v[76:79], v[140:143], v[40:43], v[76:79]
    v_mfma_f32_16x16x32_bf16 v[80:83], v[144:147], v[40:43], v[80:83]
    v_mfma_f32_16x16x32_bf16 v[84:87], v[148:151], v[40:43], v[84:87]
    v_mfma_f32_16x16x32_bf16 v[88:91], v[152:155], v[40:43], v[88:91]
    v_mfma_f32_16x16x32_bf16 v[92:95], v[156:159], v[40:43], v[92:95]
    v_mfma_f32_16x16x32_bf16 v[96:99], v[160:163], v[40:43], v[96:99]
    v_mfma_f32_16x16x32_bf16 v[100:103], v[164:167], v[40:43], v[100:103]
    v_mfma_f32_16x16x32_bf16 v[104:107], v[168:171], v[40:43], v[104:107]
    v_mfma_f32_16x16x32_bf16 v[108:111], v[172:175], v[40:43], v[108:111]
    v_mfma_f32_16x16x32_bf16 v[112:115], v[176:179], v[40:43], v[112:115]
    v_mfma_f32_16x16x32_bf16 v[116:119], v[180:183], v[40:43], v[116:119]
    v_mfma_f32_16x16x32_bf16 v[120:123], v[184:187], v[40:43], v[120:123]
    v_mfma_f32_16x16x32_bf16 v[124:127], v[188:191], v[40:43], v[124:127]
    s_add_u32 s85, s85, 1
    s_cmp_lg_u32 s85, 8
    s_cbranch_scc1 L_np6
    v_mov_b32 v47, 155876
    v_mov_b32 v46, 1
    ds_write_b32 v47, v46
L_np6:
    s_add_u32 s80, s80, 16
    s_cmp_lt_u32 s85, 9
    s_cbranch_scc1 L_loop
L_dyn:
    s_waitcnt vmcnt(16)
    ds_read_b128 v[128:131], v20 offset:0
    ds_read_b128 v[132:135], v21 offset:0
    ds_read_b128 v[136:139], v22 offset:0
    ds_read_b128 v[140:143], v23 offset:0
    ds_read_b128 v[144:147], v20 offset:256
    ds_read_b128 v[148:151], v21 offset:256
    ds_read_b128 v[152:155], v22 offset:256
    ds_read_b128 v[156:159], v23 offset:256
    ds_read_b128 v[160:163], v20 offset:8192
    ds_read_b128 v[164:167], v21 offset:8192
    ds_read_b128 v[168:171], v22 offset:8192
    ds_read_b128 v[172:175], v23 offset:8192
    ds_read_b128 v[176:179], v20 offset:8448
    ds_read_b128 v[180:183], v21 offset:8448
    ds_read_b128 v[184:187], v22 offset:8448
    ds_read_b128 v[188:191], v23 offset:8448
    s_lshr_b32 s81, s80, 1
    s_mul_i32 s81, s81, 32768
    s_and_b32 s82, s80, 1
    s_mul_i32 s82, s82, 8192
    s_add_u32 s81, s81, s82
    s_waitcnt lgkmcnt(0)
    s_waitcnt vmcnt(10)
    s_add_u32 s83, s81, 0
    s_add_u32 m0, s79, 0
    s_nop 0
    buffer_load_dwordx4 v8, s[28:31], s83 offen offset:0 nt lds
    buffer_load_dwordx4 v9, s[28:31], s83 offen offset:1024 nt lds
    s_waitcnt vmcnt(10)
    buffer_load_dwordx4 v10, s[28:31], s83 offen offset:2048 nt lds
    buffer_load_dwordx4 v11, s[28:31], s83 offen offset:3072 nt lds
    s_waitcnt vmcnt(10)
    s_add_u32 s83, s81, 4096
    s_add_u32 m0, s79, 4096
    s_nop 0
    buffer_load_dwordx4 v12, s[28:31], s83 offen offset:0 nt lds
    buffer_load_dwordx4 v13, s[28:31], s83 offen offset:1024 nt lds
    s_waitcnt vmcnt(10)
    buffer_load_dwordx4 v14, s[28:31], s83 offen offset:2048 nt lds
    buffer_load_dwordx4 v15, s[28:31], s83 offen offset:3072 nt lds
    s_waitcnt vmcnt(10)
    s_add_u32 s83, s81, 16384
    s_add_u32 m0, s79, 8192
    s_nop 0
    buffer_load_dwordx4 v8, s[28:31], s83 offen offset:0 nt lds
    buffer_load_dwordx4 v9, s[28:31], s83 offen offset:1024 nt lds
    s_waitcnt vmcnt(10)
    buffer_load_dwordx4 v10, s[28:31], s83 offen offset:2048 nt lds
    buffer_load_dwordx4 v11, s[28:31], s83 offen offset:3072 nt lds
    s_waitcnt vmcnt(10)
    s_add_u32 s83, s81, 20480
    s_add_u32 m0, s79, 12288
    s_nop 0
    buffer_load_dwordx4 v12, s[28:31], s83 offen offset:0 nt lds
    buffer_load_dwordx4 v13, s[28:31], s83 offen offset:1024 nt lds
    s_waitcnt vmcnt(10)
    buffer_load_dwordx4 v14, s[28:31], s83 offen offset:2048 nt lds
    buffer_load_dwordx4 v15, s[28:31], s83 offen offset:3072 nt lds
    v_mfma_f32_16x16x32_bf16 v[32:35], v[128:131], v[192:195], 0
    v_mfma_f32_16x16x32_bf16 v[36:39], v[160:163], v[192:195], 0
    v_mfma_f32_16x16x32_bf16 v[32:35], v[132:135], v[196:199], v[32:35]
    v_mfma_f32_16x16x32_bf16 v[36:39], v[164:167], v[196:199], v[36:39]
    v_mfma_f32_16x16x32_bf16 v[32:35], v[136:139], v[200:203], v[32:35]
    v_mfma_f32_16x16x32_bf16 v[36:39], v[168:171], v[200:203], v[36:39]
    v_mfma_f32_16x16x32_bf16 v[32:35], v[140:143], v[204:207], v[32:35]
    v_mfma_f32_16x16x32_bf16 v[36:39], v[172:175], v[204:207], v[36:39]
    v_mfma_f32_16x16x32_bf16 v[32:35], v[144:147], v[208:211], v[32:35]
    v_mfma_f32_16x16x32_bf16 v[36:39], v[176:179], v[208:211], v[36:39]
    v_mfma_f32_16x16x32_bf16 v[32:35], v[148:151], v[212:215], v[32:35]
    v_mfma_f32_16x16x32_bf16 v[36:39], v[180:183], v[212:215], v[36:39]
    v_mfma_f32_16x16x32_bf16 v[32:35], v[152:155], v[216:219], v[32:35]
    v_mfma_f32_16x16x32_bf16 v[36:39], v[184:187], v[216:219], v[36:39]
    v_mfma_f32_16x16x32_bf16 v[32:35], v[156:159], v[220:223], v[32:35]
    v_mfma_f32_16x16x32_bf16 v[36:39], v[188:191], v[220:223], v[36:39]
    s_nop 7
    v_cvt_pk_bf16_f32 v40, v32, v33
    v_cvt_pk_bf16_f32 v41, v34, v35
    v_cvt_pk_bf16_f32 v42, v36, v37
    v_cvt_pk_bf16_f32 v43, v38, v39
    v_lshlrev_b32 v32, 16, v40
    v_and_b32 v33, 0xffff0000, v40
    v_lshlrev_b32 v34, 16, v41
    v_and_b32 v35, 0xffff0000, v41
    v_lshlrev_b32 v36, 16, v42
    v_and_b32 v37, 0xffff0000, v42
    v_lshlrev_b32 v38, 16, v43
    v_and_b32 v39, 0xffff0000, v43
    v_max3_f32 v46, v32, v33, v34
    v_max3_f32 v47, v35, v36, v37
    v_max3_f32 v46, v46, v38, v39
    v_max_f32 v46, v46, v47
    v_mov_b32 v47, v46
    s_nop 1
    v_permlane32_swap_b32 v46, v47
    s_nop 1
    v_max_f32 v46, v46, v47
    v_mov_b32 v47, v46
    s_nop 1
    v_permlane16_swap_b32 v46, v47
    s_nop 1
    v_max_f32 v46, v46, v47
    v_mul_f32 v46, s84, v46
    v_max_f32 v46, v46, v44
    v_sub_f32 v47, v44, v46
    v_cmp_neq_f32 vcc, v44, v46
    v_exp_f32 v48, v47
    v_mov_b32 v44, v46
    v_fma_f32 v32, v32, s84, -v44
    v_fma_f32 v33, v33, s84, -v44
    v_fma_f32 v34, v34, s84, -v44
    v_fma_f32 v35, v35, s84, -v44
    v_fma_f32 v36, v36, s84, -v44
    v_fma_f32 v37, v37, s84, -v44
    v_fma_f32 v38, v38, s84, -v44
    v_fma_f32 v39, v39, s84, -v44
    v_exp_f32 v32, v32
    v_exp_f32 v33, v33
    v_exp_f32 v34, v34
    v_exp_f32 v35, v35
    v_exp_f32 v36, v36
    v_exp_f32 v37, v37
    v_exp_f32 v38, v38
    v_exp_f32 v39, v39
    s_cbranch_vccz L_nr7
    v_mov_b32 v49, v48
    v_mul_f32 v45, v45, v48
    v_pk_mul_f32 v[64:65], v[64:65], v[48:49]
    v_pk_mul_f32 v[66:67], v[66:67], v[48:49]
    v_pk_mul_f32 v[68:69], v[68:69], v[48:49]
    v_pk_mul_f32 v[70:71], v[70:71], v[48:49]
    v_pk_mul_f32 v[72:73], v[72:73], v[48:49]
    v_pk_mul_f32 v[74:75], v[74:75], v[48:49]
    v_pk_mul_f32 v[76:77], v[76:77], v[48:49]
    v_pk_mul_f32 v[78:79], v[78:79], v[48:49]
    v_pk_mul_f32 v[80:81], v[80:81], v[48:49]
    v_pk_mul_f32 v[82:83], v[82:83], v[48:49]
    v_pk_mul_f32 v[84:85], v[84:85], v[48:49]
    v_pk_mul_f32 v[86:87], v[86:87], v[48:49]
    v_pk_mul_f32 v[88:89], v[88:89], v[48:49]
    v_pk_mul_f32 v[90:91], v[90:91], v[48:49]
    v_pk_mul_f32 v[92:93], v[92:93], v[48:49]
    v_pk_mul_f32 v[94:95], v[94:95], v[48:49]
    v_pk_mul_f32 v[96:97], v[96:97], v[48:49]
    v_pk_mul_f32 v[98:99], v[98:99], v[48:49]
    v_pk_mul_f32 v[100:101], v[100:101], v[48:49]
    v_pk_mul_f32 v[102:103], v[102:103], v[48:49]
    v_pk_mul_f32 v[104:105], v[104:105], v[48:49]
    v_pk_mul_f32 v[106:107], v[106:107], v[48:49]
    v_pk_mul_f32 v[108:109], v[108:109], v[48:49]
    v_pk_mul_f32 v[110:111], v[110:111], v[48:49]
    v_pk_mul_f32 v[112:113], v[112:113], v[48:49]
    v_pk_mul_f32 v[114:115], v[114:115], v[48:49]
    v_pk_mul_f32 v[116:117], v[116:117], v[48:49]
    v_pk_mul_f32 v[118:119], v[118:119], v[48:49]
    v_pk_mul_f32 v[120:121], v[120:121], v[48:49]
    v_pk_mul_f32 v[122:123], v[122:123], v[48:49]
    v_pk_mul_f32 v[124:125], v[124:125], v[48:49]
    v_pk_mul_f32 v[126:127], v[126:127], v[48:49]
L_nr7:
    v_add_f32 v46, v32, v33
    v_add_f32 v47, v34, v35
    v_add_f32 v48, v36, v37
    v_add_f32 v49, v38, v39
    v_cvt_pk_bf16_f32 v40, v32, v33
    v_cvt_pk_bf16_f32 v41, v34, v35
    v_cvt_pk_bf16_f32 v42, v36, v37
    v_cvt_pk_bf16_f32 v43, v38, v39
    v_add_f32 v46, v46, v47
    v_add_f32 v48, v48, v49
    v_add_f32 v45, v45, v46
    v_add_f32 v45, v45, v48
    s_waitcnt vmcnt(16)
    ds_read_b64_tr_b16 v[128:129], v24 offset:0
    ds_read_b64_tr_b16 v[130:131], v24 offset:8192
    ds_read_b64_tr_b16 v[132:133], v25 offset:0
    ds_read_b64_tr_b16 v[134:135], v25 offset:8192
    ds_read_b64_tr_b16 v[136:137], v26 offset:0
    ds_read_b64_tr_b16 v[138:139], v26 offset:8192
    ds_read_b64_tr_b16 v[140:141], v27 offset:0
    ds_read_b64_tr_b16 v[142:143], v27 offset:8192
    ds_read_b64_tr_b16 v[144:145], v28 offset:0
    ds_read_b64_tr_b16 v[146:147], v28 offset:8192
    ds_read_b64_tr_b16 v[148:149], v29 offset:0
    ds_read_b64_tr_b16 v[150:151], v29 offset:8192
    ds_read_b64_tr_b16 v[152:153], v30 offset:0
    ds_read_b64_tr_b16 v[154:155], v30 offset:8192
    ds_read_b64_tr_b16 v[156:157], v31 offset:0
    ds_read_b64_tr_b16 v[158:159], v31 offset:8192
    ds_read_b64_tr_b16 v[160:161], v24 offset:256
    ds_read_b64_tr_b16 v[162:163], v24 offset:8448
    ds_read_b64_tr_b16 v[164:165], v25 offset:256
    ds_read_b64_tr_b16 v[166:167], v25 offset:8448
    ds_read_b64_tr_b16 v[168:169], v26 offset:256
    ds_read_b64_tr_b16 v[170:171], v26 offset:8448
    ds_read_b64_tr_b16 v[172:173], v27 offset:256
    ds_read_b64_tr_b16 v[174:175], v27 offset:8448
    ds_read_b64_tr_b16 v[176:177], v28 offset:256
    ds_read_b64_tr_b16 v[178:179], v28 offset:8448
    ds_read_b64_tr_b16 v[180:181], v29 offset:256
    ds_read_b64_tr_b16 v[182:183], v29 offset:8448
    ds_read_b64_tr_b16 v[184:185], v30 offset:256
    ds_read_b64_tr_b16 v[186:187], v30 offset:8448
    ds_read_b64_tr_b16 v[188:189], v31 offset:256
    ds_read_b64_tr_b16 v[190:191], v31 offset:8448
    s_waitcnt lgkmcnt(0)
    s_mov_b64 exec, 1
    v_mov_b32 v60, 1
    buffer_atomic_add v60, v61, s[68:71], 0 offen sc0 sc1
    s_mov_b64 exec, -1
    s_waitcnt vmcnt(10)
    s_add_u32 s83, s81, 0
    s_add_u32 m0, s79, 16384
    s_nop 0
    buffer_load_dwordx4 v16, s[32:35], s83 offen offset:0 nt lds
    buffer_load_dwordx4 v17, s[32:35], s83 offen offset:1024 nt lds
    s_waitcnt vmcnt(10)
    buffer_load_dwordx4 v18, s[32:35], s83 offen offset:2048 nt lds
    buffer_load_dwordx4 v19, s[32:35], s83 offen offset:3072 nt lds
    s_waitcnt vmcnt(10)
    s_add_u32 s83, s81, 4096
    s_add_u32 m0, s79, 20480
    s_nop 0
    buffer_load_dwordx4 v16, s[32:35], s83 offen offset:0 nt lds
    buffer_load_dwordx4 v17, s[32:35], s83 offen offset:1024 nt lds
    s_waitcnt vmcnt(10)
    buffer_load_dwordx4 v18, s[32:35], s83 offen offset:2048 nt lds
    buffer_load_dwordx4 v19, s[32:35], s83 offen offset:3072 nt lds
    s_waitcnt vmcnt(10)
    s_add_u32 s83, s81, 16384
    s_add_u32 m0, s79, 24576
    s_nop 0
    buffer_load_dwordx4 v16, s[32:35], s83 offen offset:0 nt lds
    buffer_load_dwordx4 v17, s[32:35], s83 offen offset:1024 nt lds
    s_waitcnt vmcnt(10)
    buffer_load_dwordx4 v18, s[32:35], s83 offen offset:2048 nt lds
    buffer_load_dwordx4 v19, s[32:35], s83 offen offset:3072 nt lds
    s_waitcnt vmcnt(10)
    s_add_u32 s83, s81, 20480
    s_add_u32 m0, s79, 28672
    s_nop 0
    buffer_load_dwordx4 v16, s[32:35], s83 offen offset:0 nt lds
    buffer_load_dwordx4 v17, s[32:35], s83 offen offset:1024 nt lds
    s_waitcnt vmcnt(10)
    buffer_load_dwordx4 v18, s[32:35], s83 offen offset:2048 nt lds
    buffer_load_dwordx4 v19, s[32:35], s83 offen offset:3072 nt lds
    v_mfma_f32_16x16x32_bf16 v[64:67], v[128:131], v[40:43], v[64:67]
    v_mfma_f32_16x16x32_bf16 v[68:71], v[132:135], v[40:43], v[68:71]
    v_mfma_f32_16x16x32_bf16 v[72:75], v[136:139], v[40:43], v[72:75]
    v_mfma_f32_16x16x32_bf16 v[76:79], v[140:143], v[40:43], v[76:79]
    v_mfma_f32_16x16x32_bf16 v[80:83], v[144:147], v[40:43], v[80:83]
    v_mfma_f32_16x16x32_bf16 v[84:87], v[148:151], v[40:43], v[84:87]
    v_mfma_f32_16x16x32_bf16 v[88:91], v[152:155], v[40:43], v[88:91]
    v_mfma_f32_16x16x32_bf16 v[92:95], v[156:159], v[40:43], v[92:95]
    v_mfma_f32_16x16x32_bf16 v[96:99], v[160:163], v[40:43], v[96:99]
    v_mfma_f32_16x16x32_bf16 v[100:103], v[164:167], v[40:43], v[100:103]
    v_mfma_f32_16x16x32_bf16 v[104:107], v[168:171], v[40:43], v[104:107]
    v_mfma_f32_16x16x32_bf16 v[108:111], v[172:175], v[40:43], v[108:111]
    v_mfma_f32_16x16x32_bf16 v[112:115], v[176:179], v[40:43], v[112:115]
    v_mfma_f32_16x16x32_bf16 v[116:119], v[180:183], v[40:43], v[116:119]
    v_mfma_f32_16x16x32_bf16 v[120:123], v[184:187], v[40:43], v[120:123]
    v_mfma_f32_16x16x32_bf16 v[124:127], v[188:191], v[40:43], v[124:127]
    s_add_u32 s85, s85, 1
    s_cmp_lg_u32 s85, 8
    s_cbranch_scc1 L_np8
    v_mov_b32 v47, 155876
    v_mov_b32 v46, 1
    ds_write_b32 v47, v46
L_np8:
    s_waitcnt vmcnt(16)
    v_readfirstlane_b32 s80, v60
    s_add_u32 s80, s80, 176
    s_cmp_lt_u32 s80, 240
    s_cbranch_scc1 L_dyn
    s_cmp_lt_u32 s80, 272
    s_cbranch_scc1 L_tr
    v_mov_b32 v47, 155876
    v_mov_b32 v46, 1
    ds_write_b32 v47, v46
    v_mov_b32 v47, 155844
    s_mov_b32 s96, 0
L_sp9:
    ds_read_b32 v46, v47
    s_waitcnt lgkmcnt(0)
    v_readfirstlane_b32 s95, v46
    s_cmp_ge_u32 s95, 1
    s_cbranch_scc1 L_sd10
    s_sleep 1
    s_add_u32 s96, s96, 1
    s_cmp_lt_u32 s96, 2097152
    s_cbranch_scc1 L_sp9
L_sd10:
    v_mov_b32 v46, 155852
    v_mov_b32 v47, 1
    s_mov_b64 exec, 1
    ds_add_u32 v46, v47
    s_mov_b64 exec, -1
    s_waitcnt vmcnt(16)
    ds_read_b128 v[128:131], v20 offset:0
    ds_read_b128 v[132:135], v21 offset:0
    ds_read_b128 v[136:139], v22 offset:0
    ds_read_b128 v[140:143], v23 offset:0
    ds_read_b128 v[144:147], v20 offset:256
    ds_read_b128 v[148:151], v21 offset:256
    ds_read_b128 v[152:155], v22 offset:256
    ds_read_b128 v[156:159], v23 offset:256
    ds_read_b128 v[160:163], v20 offset:8192
    ds_read_b128 v[164:167], v21 offset:8192
    ds_read_b128 v[168:171], v22 offset:8192
    ds_read_b128 v[172:175], v23 offset:8192
    ds_read_b128 v[176:179], v20 offset:8448
    ds_read_b128 v[180:183], v21 offset:8448
    ds_read_b128 v[184:187], v22 offset:8448
    ds_read_b128 v[188:191], v23 offset:8448
    s_waitcnt lgkmcnt(0)
    v_mfma_f32_16x16x32_bf16 v[32:35], v[128:131], v[192:195], 0
    v_mfma_f32_16x16x32_bf16 v[36:39], v[160:163], v[192:195], 0
    v_mfma_f32_16x16x32_bf16 v[32:35], v[132:135], v[196:199], v[32:35]
    v_mfma_f32_16x16x32_bf16 v[36:39], v[164:167], v[196:199], v[36:39]
    v_mfma_f32_16x16x32_bf16 v[32:35], v[136:139], v[200:203], v[32:35]
    v_mfma_f32_16x16x32_bf16 v[36:39], v[168:171], v[200:203], v[36:39]
    v_mfma_f32_16x16x32_bf16 v[32:35], v[140:143], v[204:207], v[32:35]
    v_mfma_f32_16x16x32_bf16 v[36:39], v[172:175], v[204:207], v[36:39]
    v_mfma_f32_16x16x32_bf16 v[32:35], v[144:147], v[208:211], v[32:35]
    v_mfma_f32_16x16x32_bf16 v[36:39], v[176:179], v[208:211], v[36:39]
    v_mfma_f32_16x16x32_bf16 v[32:35], v[148:151], v[212:215], v[32:35]
    v_mfma_f32_16x16x32_bf16 v[36:39], v[180:183], v[212:215], v[36:39]
    v_mfma_f32_16x16x32_bf16 v[32:35], v[152:155], v[216:219], v[32:35]
    v_mfma_f32_16x16x32_bf16 v[36:39], v[184:187], v[216:219], v[36:39]
    v_mfma_f32_16x16x32_bf16 v[32:35], v[156:159], v[220:223], v[32:35]
    v_mfma_f32_16x16x32_bf16 v[36:39], v[188:191], v[220:223], v[36:39]
    s_nop 7
    v_cvt_pk_bf16_f32 v40, v32, v33
    v_cvt_pk_bf16_f32 v41, v34, v35
    v_cvt_pk_bf16_f32 v42, v36, v37
    v_cvt_pk_bf16_f32 v43, v38, v39
    v_lshlrev_b32 v32, 16, v40
    v_and_b32 v33, 0xffff0000, v40
    v_lshlrev_b32 v34, 16, v41
    v_and_b32 v35, 0xffff0000, v41
    v_lshlrev_b32 v36, 16, v42
    v_and_b32 v37, 0xffff0000, v42
    v_lshlrev_b32 v38, 16, v43
    v_and_b32 v39, 0xffff0000, v43
    v_max3_f32 v46, v32, v33, v34
    v_max3_f32 v47, v35, v36, v37
    v_max3_f32 v46, v46, v38, v39
    v_max_f32 v46, v46, v47
    v_mov_b32 v47, v46
    s_nop 1
    v_permlane32_swap_b32 v46, v47
    s_nop 1
    v_max_f32 v46, v46, v47
    v_mov_b32 v47, v46
    s_nop 1
    v_permlane16_swap_b32 v46, v47
    s_nop 1
    v_max_f32 v46, v46, v47
    v_mul_f32 v46, s84, v46
    v_max_f32 v46, v46, v44
    v_sub_f32 v47, v44, v46
    v_cmp_neq_f32 vcc, v44, v46
    v_exp_f32 v48, v47
    v_mov_b32 v44, v46
    v_fma_f32 v32, v32, s84, -v44
    v_fma_f32 v33, v33, s84, -v44
    v_fma_f32 v34, v34, s84, -v44
    v_fma_f32 v35, v35, s84, -v44
    v_fma_f32 v36, v36, s84, -v44
    v_fma_f32 v37, v37, s84, -v44
    v_fma_f32 v38, v38, s84, -v44
    v_fma_f32 v39, v39, s84, -v44
    v_exp_f32 v32, v32
    v_exp_f32 v33, v33
    v_exp_f32 v34, v34
    v_exp_f32 v35, v35
    v_exp_f32 v36, v36
    v_exp_f32 v37, v37
    v_exp_f32 v38, v38
    v_exp_f32 v39, v39
    s_cbranch_vccz L_nr11
    v_mov_b32 v49, v48
    v_mul_f32 v45, v45, v48
    v_pk_mul_f32 v[64:65], v[64:65], v[48:49]
    v_pk_mul_f32 v[66:67], v[66:67], v[48:49]
    v_pk_mul_f32 v[68:69], v[68:69], v[48:49]
    v_pk_mul_f32 v[70:71], v[70:71], v[48:49]
    v_pk_mul_f32 v[72:73], v[72:73], v[48:49]
    v_pk_mul_f32 v[74:75], v[74:75], v[48:49]
    v_pk_mul_f32 v[76:77], v[76:77], v[48:49]
    v_pk_mul_f32 v[78:79], v[78:79], v[48:49]
    v_pk_mul_f32 v[80:81], v[80:81], v[48:49]
    v_pk_mul_f32 v[82:83], v[82:83], v[48:49]
    v_pk_mul_f32 v[84:85], v[84:85], v[48:49]
    v_pk_mul_f32 v[86:87], v[86:87], v[48:49]
    v_pk_mul_f32 v[88:89], v[88:89], v[48:49]
    v_pk_mul_f32 v[90:91], v[90:91], v[48:49]
    v_pk_mul_f32 v[92:93], v[92:93], v[48:49]
    v_pk_mul_f32 v[94:95], v[94:95], v[48:49]
    v_pk_mul_f32 v[96:97], v[96:97], v[48:49]
    v_pk_mul_f32 v[98:99], v[98:99], v[48:49]
    v_pk_mul_f32 v[100:101], v[100:101], v[48:49]
    v_pk_mul_f32 v[102:103], v[102:103], v[48:49]
    v_pk_mul_f32 v[104:105], v[104:105], v[48:49]
    v_pk_mul_f32 v[106:107], v[106:107], v[48:49]
    v_pk_mul_f32 v[108:109], v[108:109], v[48:49]
    v_pk_mul_f32 v[110:111], v[110:111], v[48:49]
    v_pk_mul_f32 v[112:113], v[112:113], v[48:49]
    v_pk_mul_f32 v[114:115], v[114:115], v[48:49]
    v_pk_mul_f32 v[116:117], v[116:117], v[48:49]
    v_pk_mul_f32 v[118:119], v[118:119], v[48:49]
    v_pk_mul_f32 v[120:121], v[120:121], v[48:49]
    v_pk_mul_f32 v[122:123], v[122:123], v[48:49]
    v_pk_mul_f32 v[124:125], v[124:125], v[48:49]
    v_pk_mul_f32 v[126:127], v[126:127], v[48:49]
L_nr11:
    v_add_f32 v46, v32, v33
    v_add_f32 v47, v34, v35
    v_add_f32 v48, v36, v37
    v_add_f32 v49, v38, v39
    v_cvt_pk_bf16_f32 v40, v32, v33
    v_cvt_pk_bf16_f32 v41, v34, v35
    v_cvt_pk_bf16_f32 v42, v36, v37
    v_cvt_pk_bf16_f32 v43, v38, v39
    v_add_f32 v46, v46, v47
    v_add_f32 v48, v48, v49
    v_add_f32 v45, v45, v46
    v_add_f32 v45, v45, v48
    v_mov_b32 v46, v45
    s_nop 1
    v_permlane32_swap_b32 v45, v46
    s_nop 1
    v_add_f32 v45, v45, v46
    v_mov_b32 v46, v45
    s_nop 1
    v_permlane16_swap_b32 v45, v46
    s_nop 1
    v_add_f32 v45, v45, v46
    v_lshlrev_b32 v46, 10, v6
    v_lshl_add_u32 v46, v7, 4, v46
    v_add_u32 v46, s79, v46
    s_lshl_b32 s86, s74, 4
    s_add_u32 s86, s86, 155904
    v_lshl_add_u32 v47, v0, 2, s86
    s_mov_b64 exec, 3
    ds_write2_b32 v47, v44, v45 offset0:0 offset1:2
    s_mov_b64 exec, -1
    s_waitcnt vmcnt(8)
    ds_read_b64_tr_b16 v[128:129], v24 offset:0
    ds_read_b64_tr_b16 v[132:133], v25 offset:0
    ds_read_b64_tr_b16 v[136:137], v26 offset:0
    ds_read_b64_tr_b16 v[140:141], v27 offset:0
    ds_read_b64_tr_b16 v[144:145], v28 offset:0
    ds_read_b64_tr_b16 v[148:149], v29 offset:0
    ds_read_b64_tr_b16 v[152:153], v30 offset:0
    ds_read_b64_tr_b16 v[156:157], v31 offset:0
    ds_read_b64_tr_b16 v[160:161], v24 offset:256
    ds_read_b64_tr_b16 v[164:165], v25 offset:256
    ds_read_b64_tr_b16 v[168:169], v26 offset:256
    ds_read_b64_tr_b16 v[172:173], v27 offset:256
    ds_read_b64_tr_b16 v[176:177], v28 offset:256
    ds_read_b64_tr_b16 v[180:181], v29 offset:256
    ds_read_b64_tr_b16 v[184:185], v30 offset:256
    ds_read_b64_tr_b16 v[188:189], v31 offset:256
    s_waitcnt vmcnt(0)
    ds_read_b64_tr_b16 v[130:131], v24 offset:8192
    ds_read_b64_tr_b16 v[134:135], v25 offset:8192
    ds_read_b64_tr_b16 v[138:139], v26 offset:8192
    ds_read_b64_tr_b16 v[142:143], v27 offset:8192
    ds_read_b64_tr_b16 v[146:147], v28 offset:8192
    ds_read_b64_tr_b16 v[150:151], v29 offset:8192
    ds_read_b64_tr_b16 v[154:155], v30 offset:8192
    ds_read_b64_tr_b16 v[158:159], v31 offset:8192
    ds_read_b64_tr_b16 v[162:163], v24 offset:8448
    ds_read_b64_tr_b16 v[166:167], v25 offset:8448
    ds_read_b64_tr_b16 v[170:171], v26 offset:8448
    ds_read_b64_tr_b16 v[174:175], v27 offset:8448
    ds_read_b64_tr_b16 v[178:179], v28 offset:8448
    ds_read_b64_tr_b16 v[182:183], v29 offset:8448
    ds_read_b64_tr_b16 v[186:187], v30 offset:8448
    ds_read_b64_tr_b16 v[190:191], v31 offset:8448
    s_waitcnt lgkmcnt(15)
    v_mfma_f32_16x16x32_bf16 v[64:67], v[128:131], v[40:43], v[64:67]
    s_waitcnt lgkmcnt(14)
    v_mfma_f32_16x16x32_bf16 v[68:71], v[132:135], v[40:43], v[68:71]
    s_waitcnt lgkmcnt(13)
    v_mfma_f32_16x16x32_bf16 v[72:75], v[136:139], v[40:43], v[72:75]
    s_waitcnt lgkmcnt(12)
    v_mfma_f32_16x16x32_bf16 v[76:79], v[140:143], v[40:43], v[76:79]
    s_waitcnt lgkmcnt(11)
    v_mfma_f32_16x16x32_bf16 v[80:83], v[144:147], v[40:43], v[80:83]
    s_waitcnt lgkmcnt(10)
    v_mfma_f32_16x16x32_bf16 v[84:87], v[148:151], v[40:43], v[84:87]
    s_waitcnt lgkmcnt(9)
    v_mfma_f32_16x16x32_bf16 v[88:91], v[152:155], v[40:43], v[88:91]
    s_waitcnt lgkmcnt(8)
    v_mfma_f32_16x16x32_bf16 v[92:95], v[156:159], v[40:43], v[92:95]
    s_waitcnt lgkmcnt(7)
    v_mfma_f32_16x16x32_bf16 v[96:99], v[160:163], v[40:43], v[96:99]
    s_waitcnt lgkmcnt(6)
    v_mfma_f32_16x16x32_bf16 v[100:103], v[164:167], v[40:43], v[100:103]
    s_waitcnt lgkmcnt(5)
    v_mfma_f32_16x16x32_bf16 v[104:107], v[168:171], v[40:43], v[104:107]
    s_waitcnt lgkmcnt(4)
    v_mfma_f32_16x16x32_bf16 v[108:111], v[172:175], v[40:43], v[108:111]
    s_waitcnt lgkmcnt(3)
    v_mfma_f32_16x16x32_bf16 v[112:115], v[176:179], v[40:43], v[112:115]
    s_waitcnt lgkmcnt(2)
    v_mfma_f32_16x16x32_bf16 v[116:119], v[180:183], v[40:43], v[116:119]
    s_waitcnt lgkmcnt(1)
    v_mfma_f32_16x16x32_bf16 v[120:123], v[184:187], v[40:43], v[120:123]
    s_waitcnt lgkmcnt(0)
    v_mfma_f32_16x16x32_bf16 v[124:127], v[188:191], v[40:43], v[124:127]
    s_branch L_merge
L_tr:
    s_waitcnt vmcnt(16)
    ds_read_b128 v[128:131], v20 offset:0
    ds_read_b128 v[132:135], v21 offset:0
    ds_read_b128 v[136:139], v22 offset:0
    ds_read_b128 v[140:143], v23 offset:0
    ds_read_b128 v[144:147], v20 offset:256
    ds_read_b128 v[148:151], v21 offset:256
    ds_read_b128 v[152:155], v22 offset:256
    ds_read_b128 v[156:159], v23 offset:256
    ds_read_b128 v[160:163], v20 offset:8192
    ds_read_b128 v[164:167], v21 offset:8192
    ds_read_b128 v[168:171], v22 offset:8192
    ds_read_b128 v[172:175], v23 offset:8192
    ds_read_b128 v[176:179], v20 offset:8448
    ds_read_b128 v[180:183], v21 offset:8448
    ds_read_b128 v[184:187], v22 offset:8448
    ds_read_b128 v[188:191], v23 offset:8448
    s_lshl_b32 s81, s80, 13
    s_add_u32 s81, s81, 1966080
    s_waitcnt lgkmcnt(0)
    s_waitcnt vmcnt(10)
    s_add_u32 s83, s81, 0
    s_add_u32 m0, s79, 0
    s_nop 0
    buffer_load_dwordx4 v8, s[28:31], s83 offen offset:0 nt lds
    buffer_load_dwordx4 v9, s[28:31], s83 offen offset:1024 nt lds
    s_waitcnt vmcnt(10)
    buffer_load_dwordx4 v10, s[28:31], s83 offen offset:2048 nt lds
    buffer_load_dwordx4 v11, s[28:31], s83 offen offset:3072 nt lds
    s_waitcnt vmcnt(10)
    s_add_u32 s83, s81, 4096
    s_add_u32 m0, s79, 4096
    s_nop 0
    buffer_load_dwordx4 v12, s[28:31], s83 offen offset:0 nt lds
    buffer_load_dwordx4 v13, s[28:31], s83 offen offset:1024 nt lds
    s_waitcnt vmcnt(10)
    buffer_load_dwordx4 v14, s[28:31], s83 offen offset:2048 nt lds
    buffer_load_dwordx4 v15, s[28:31], s83 offen offset:3072 nt lds
    v_mfma_f32_16x16x32_bf16 v[32:35], v[128:131], v[192:195], 0
    v_mfma_f32_16x16x32_bf16 v[36:39], v[160:163], v[192:195], 0
    v_mfma_f32_16x16x32_bf16 v[32:35], v[132:135], v[196:199], v[32:35]
    v_mfma_f32_16x16x32_bf16 v[36:39], v[164:167], v[196:199], v[36:39]
    v_mfma_f32_16x16x32_bf16 v[32:35], v[136:139], v[200:203], v[32:35]
    v_mfma_f32_16x16x32_bf16 v[36:39], v[168:171], v[200:203], v[36:39]
    v_mfma_f32_16x16x32_bf16 v[32:35], v[140:143], v[204:207], v[32:35]
    v_mfma_f32_16x16x32_bf16 v[36:39], v[172:175], v[204:207], v[36:39]
    v_mfma_f32_16x16x32_bf16 v[32:35], v[144:147], v[208:211], v[32:35]
    v_mfma_f32_16x16x32_bf16 v[36:39], v[176:179], v[208:211], v[36:39]
    v_mfma_f32_16x16x32_bf16 v[32:35], v[148:151], v[212:215], v[32:35]
    v_mfma_f32_16x16x32_bf16 v[36:39], v[180:183], v[212:215], v[36:39]
    v_mfma_f32_16x16x32_bf16 v[32:35], v[152:155], v[216:219], v[32:35]
    v_mfma_f32_16x16x32_bf16 v[36:39], v[184:187], v[216:219], v[36:39]
    v_mfma_f32_16x16x32_bf16 v[32:35], v[156:159], v[220:223], v[32:35]
    v_mfma_f32_16x16x32_bf16 v[36:39], v[188:191], v[220:223], v[36:39]
    s_nop 7
    v_cvt_pk_bf16_f32 v40, v32, v33
    v_cvt_pk_bf16_f32 v41, v34, v35
    v_cvt_pk_bf16_f32 v42, v36, v37
    v_cvt_pk_bf16_f32 v43, v38, v39
    v_lshlrev_b32 v32, 16, v40
    v_and_b32 v33, 0xffff0000, v40
    v_lshlrev_b32 v34, 16, v41
    v_and_b32 v35, 0xffff0000, v41
    v_lshlrev_b32 v36, 16, v42
    v_and_b32 v37, 0xffff0000, v42
    v_lshlrev_b32 v38, 16, v43
    v_and_b32 v39, 0xffff0000, v43
    v_max3_f32 v46, v32, v33, v34
    v_max3_f32 v47, v35, v36, v37
    v_max3_f32 v46, v46, v38, v39
    v_max_f32 v46, v46, v47
    v_mov_b32 v47, v46
    s_nop 1
    v_permlane32_swap_b32 v46, v47
    s_nop 1
    v_max_f32 v46, v46, v47
    v_mov_b32 v47, v46
    s_nop 1
    v_permlane16_swap_b32 v46, v47
    s_nop 1
    v_max_f32 v46, v46, v47
    v_mul_f32 v46, s84, v46
    v_max_f32 v46, v46, v44
    v_sub_f32 v47, v44, v46
    v_cmp_neq_f32 vcc, v44, v46
    v_exp_f32 v48, v47
    v_mov_b32 v44, v46
    v_fma_f32 v32, v32, s84, -v44
    v_fma_f32 v33, v33, s84, -v44
    v_fma_f32 v34, v34, s84, -v44
    v_fma_f32 v35, v35, s84, -v44
    v_fma_f32 v36, v36, s84, -v44
    v_fma_f32 v37, v37, s84, -v44
    v_fma_f32 v38, v38, s84, -v44
    v_fma_f32 v39, v39, s84, -v44
    v_exp_f32 v32, v32
    v_exp_f32 v33, v33
    v_exp_f32 v34, v34
    v_exp_f32 v35, v35
    v_exp_f32 v36, v36
    v_exp_f32 v37, v37
    v_exp_f32 v38, v38
    v_exp_f32 v39, v39
    s_cbranch_vccz L_nr12
    v_mov_b32 v49, v48
    v_mul_f32 v45, v45, v48
    v_pk_mul_f32 v[64:65], v[64:65], v[48:49]
    v_pk_mul_f32 v[66:67], v[66:67], v[48:49]
    v_pk_mul_f32 v[68:69], v[68:69], v[48:49]
    v_pk_mul_f32 v[70:71], v[70:71], v[48:49]
    v_pk_mul_f32 v[72:73], v[72:73], v[48:49]
    v_pk_mul_f32 v[74:75], v[74:75], v[48:49]
    v_pk_mul_f32 v[76:77], v[76:77], v[48:49]
    v_pk_mul_f32 v[78:79], v[78:79], v[48:49]
    v_pk_mul_f32 v[80:81], v[80:81], v[48:49]
    v_pk_mul_f32 v[82:83], v[82:83], v[48:49]
    v_pk_mul_f32 v[84:85], v[84:85], v[48:49]
    v_pk_mul_f32 v[86:87], v[86:87], v[48:49]
    v_pk_mul_f32 v[88:89], v[88:89], v[48:49]
    v_pk_mul_f32 v[90:91], v[90:91], v[48:49]
    v_pk_mul_f32 v[92:93], v[92:93], v[48:49]
    v_pk_mul_f32 v[94:95], v[94:95], v[48:49]
    v_pk_mul_f32 v[96:97], v[96:97], v[48:49]
    v_pk_mul_f32 v[98:99], v[98:99], v[48:49]
    v_pk_mul_f32 v[100:101], v[100:101], v[48:49]
    v_pk_mul_f32 v[102:103], v[102:103], v[48:49]
    v_pk_mul_f32 v[104:105], v[104:105], v[48:49]
    v_pk_mul_f32 v[106:107], v[106:107], v[48:49]
    v_pk_mul_f32 v[108:109], v[108:109], v[48:49]
    v_pk_mul_f32 v[110:111], v[110:111], v[48:49]
    v_pk_mul_f32 v[112:113], v[112:113], v[48:49]
    v_pk_mul_f32 v[114:115], v[114:115], v[48:49]
    v_pk_mul_f32 v[116:117], v[116:117], v[48:49]
    v_pk_mul_f32 v[118:119], v[118:119], v[48:49]
    v_pk_mul_f32 v[120:121], v[120:121], v[48:49]
    v_pk_mul_f32 v[122:123], v[122:123], v[48:49]
    v_pk_mul_f32 v[124:125], v[124:125], v[48:49]
    v_pk_mul_f32 v[126:127], v[126:127], v[48:49]
L_nr12:
    v_add_f32 v46, v32, v33
    v_add_f32 v47, v34, v35
    v_add_f32 v48, v36, v37
    v_add_f32 v49, v38, v39
    v_cvt_pk_bf16_f32 v40, v32, v33
    v_cvt_pk_bf16_f32 v41, v34, v35
    v_cvt_pk_bf16_f32 v42, v36, v37
    v_cvt_pk_bf16_f32 v43, v38, v39
    v_add_f32 v46, v46, v47
    v_add_f32 v48, v48, v49
    v_add_f32 v45, v45, v46
    v_add_f32 v45, v45, v48
    s_waitcnt vmcnt(8)
    ds_read_b64_tr_b16 v[128:129], v24 offset:0
    ds_read_b64_tr_b16 v[130:131], v24 offset:8192
    ds_read_b64_tr_b16 v[132:133], v25 offset:0
    ds_read_b64_tr_b16 v[134:135], v25 offset:8192
    ds_read_b64_tr_b16 v[136:137], v26 offset:0
    ds_read_b64_tr_b16 v[138:139], v26 offset:8192
    ds_read_b64_tr_b16 v[140:141], v27 offset:0
    ds_read_b64_tr_b16 v[142:143], v27 offset:8192
    ds_read_b64_tr_b16 v[144:145], v28 offset:0
    ds_read_b64_tr_b16 v[146:147], v28 offset:8192
    ds_read_b64_tr_b16 v[148:149], v29 offset:0
    ds_read_b64_tr_b16 v[150:151], v29 offset:8192
    ds_read_b64_tr_b16 v[152:153], v30 offset:0
    ds_read_b64_tr_b16 v[154:155], v30 offset:8192
    ds_read_b64_tr_b16 v[156:157], v31 offset:0
    ds_read_b64_tr_b16 v[158:159], v31 offset:8192
    ds_read_b64_tr_b16 v[160:161], v24 offset:256
    ds_read_b64_tr_b16 v[162:163], v24 offset:8448
    ds_read_b64_tr_b16 v[164:165], v25 offset:256
    ds_read_b64_tr_b16 v[166:167], v25 offset:8448
    ds_read_b64_tr_b16 v[168:169], v26 offset:256
    ds_read_b64_tr_b16 v[170:171], v26 offset:8448
    ds_read_b64_tr_b16 v[172:173], v27 offset:256
    ds_read_b64_tr_b16 v[174:175], v27 offset:8448
    ds_read_b64_tr_b16 v[176:177], v28 offset:256
    ds_read_b64_tr_b16 v[178:179], v28 offset:8448
    ds_read_b64_tr_b16 v[180:181], v29 offset:256
    ds_read_b64_tr_b16 v[182:183], v29 offset:8448
    ds_read_b64_tr_b16 v[184:185], v30 offset:256
    ds_read_b64_tr_b16 v[186:187], v30 offset:8448
    ds_read_b64_tr_b16 v[188:189], v31 offset:256
    ds_read_b64_tr_b16 v[190:191], v31 offset:8448
    s_waitcnt lgkmcnt(0)
    s_mov_b64 exec, 1
    v_mov_b32 v60, 1
    buffer_atomic_add v60, v61, s[68:71], 0 offen sc0 sc1
    s_mov_b64 exec, -1
    s_waitcnt vmcnt(10)
    s_add_u32 s83, s81, 0
    s_add_u32 m0, s79, 16384
    s_nop 0
    buffer_load_dwordx4 v16, s[32:35], s83 offen offset:0 nt lds
    buffer_load_dwordx4 v17, s[32:35], s83 offen offset:1024 nt lds
    s_waitcnt vmcnt(10)
    buffer_load_dwordx4 v18, s[32:35], s83 offen offset:2048 nt lds
    buffer_load_dwordx4 v19, s[32:35], s83 offen offset:3072 nt lds
    s_waitcnt vmcnt(10)
    s_add_u32 s83, s81, 4096
    s_add_u32 m0, s79, 20480
    s_nop 0
    buffer_load_dwordx4 v16, s[32:35], s83 offen offset:0 nt lds
    buffer_load_dwordx4 v17, s[32:35], s83 offen offset:1024 nt lds
    s_waitcnt vmcnt(10)
    buffer_load_dwordx4 v18, s[32:35], s83 offen offset:2048 nt lds
    buffer_load_dwordx4 v19, s[32:35], s83 offen offset:3072 nt lds
    v_mfma_f32_16x16x32_bf16 v[64:67], v[128:131], v[40:43], v[64:67]
    v_mfma_f32_16x16x32_bf16 v[68:71], v[132:135], v[40:43], v[68:71]
    v_mfma_f32_16x16x32_bf16 v[72:75], v[136:139], v[40:43], v[72:75]
    v_mfma_f32_16x16x32_bf16 v[76:79], v[140:143], v[40:43], v[76:79]
    v_mfma_f32_16x16x32_bf16 v[80:83], v[144:147], v[40:43], v[80:83]
    v_mfma_f32_16x16x32_bf16 v[84:87], v[148:151], v[40:43], v[84:87]
    v_mfma_f32_16x16x32_bf16 v[88:91], v[152:155], v[40:43], v[88:91]
    v_mfma_f32_16x16x32_bf16 v[92:95], v[156:159], v[40:43], v[92:95]
    v_mfma_f32_16x16x32_bf16 v[96:99], v[160:163], v[40:43], v[96:99]
    v_mfma_f32_16x16x32_bf16 v[100:103], v[164:167], v[40:43], v[100:103]
    v_mfma_f32_16x16x32_bf16 v[104:107], v[168:171], v[40:43], v[104:107]
    v_mfma_f32_16x16x32_bf16 v[108:111], v[172:175], v[40:43], v[108:111]
    v_mfma_f32_16x16x32_bf16 v[112:115], v[176:179], v[40:43], v[112:115]
    v_mfma_f32_16x16x32_bf16 v[116:119], v[180:183], v[40:43], v[116:119]
    v_mfma_f32_16x16x32_bf16 v[120:123], v[184:187], v[40:43], v[120:123]
    v_mfma_f32_16x16x32_bf16 v[124:127], v[188:191], v[40:43], v[124:127]
    s_waitcnt vmcnt(8)
    v_readfirstlane_b32 s80, v60
    s_add_u32 s80, s80, 176
    s_cmp_ge_u32 s80, 272
    s_cbranch_scc1 L_hl
L_half:
    s_waitcnt vmcnt(8)
    ds_read_b128 v[128:131], v20 offset:0
    ds_read_b128 v[132:135], v21 offset:0
    ds_read_b128 v[136:139], v22 offset:0
    ds_read_b128 v[140:143], v23 offset:0
    ds_read_b128 v[144:147], v20 offset:256
    ds_read_b128 v[148:151], v21 offset:256
    ds_read_b128 v[152:155], v22 offset:256
    ds_read_b128 v[156:159], v23 offset:256
    s_lshl_b32 s81, s80, 13
    s_add_u32 s81, s81, 1966080
    s_waitcnt lgkmcnt(0)
    s_waitcnt vmcnt(10)
    s_add_u32 s83, s81, 0
    s_add_u32 m0, s79, 0
    s_nop 0
    buffer_load_dwordx4 v8, s[28:31], s83 offen offset:0 nt lds
    buffer_load_dwordx4 v9, s[28:31], s83 offen offset:1024 nt lds
    s_waitcnt vmcnt(10)
    buffer_load_dwordx4 v10, s[28:31], s83 offen offset:2048 nt lds
    buffer_load_dwordx4 v11, s[28:31], s83 offen offset:3072 nt lds
    s_waitcnt vmcnt(10)
    s_add_u32 s83, s81, 4096
    s_add_u32 m0, s79, 4096
    s_nop 0
    buffer_load_dwordx4 v12, s[28:31], s83 offen offset:0 nt lds
    buffer_load_dwordx4 v13, s[28:31], s83 offen offset:1024 nt lds
    s_waitcnt vmcnt(10)
    buffer_load_dwordx4 v14, s[28:31], s83 offen offset:2048 nt lds
    buffer_load_dwordx4 v15, s[28:31], s83 offen offset:3072 nt lds
    v_mfma_f32_16x16x32_bf16 v[32:35], v[128:131], v[192:195], 0
    v_mfma_f32_16x16x32_bf16 v[32:35], v[132:135], v[196:199], v[32:35]
    v_mfma_f32_16x16x32_bf16 v[32:35], v[136:139], v[200:203], v[32:35]
    v_mfma_f32_16x16x32_bf16 v[32:35], v[140:143], v[204:207], v[32:35]
    v_mfma_f32_16x16x32_bf16 v[32:35], v[144:147], v[208:211], v[32:35]
    v_mfma_f32_16x16x32_bf16 v[32:35], v[148:151], v[212:215], v[32:35]
    v_mfma_f32_16x16x32_bf16 v[32:35], v[152:155], v[216:219], v[32:35]
    v_mfma_f32_16x16x32_bf16 v[32:35], v[156:159], v[220:223], v[32:35]
    s_nop 7
    v_cvt_pk_bf16_f32 v40, v32, v33
    v_cvt_pk_bf16_f32 v41, v34, v35
    v_lshlrev_b32 v32, 16, v40
    v_and_b32 v33, 0xffff0000, v40
    v_lshlrev_b32 v34, 16, v41
    v_and_b32 v35, 0xffff0000, v41
    v_max3_f32 v46, v32, v33, v34
    v_max_f32 v46, v46, v35
    v_mov_b32 v47, v46
    s_nop 1
    v_permlane32_swap_b32 v46, v47
    s_nop 1
    v_max_f32 v46, v46, v47
    v_mov_b32 v47, v46
    s_nop 1
    v_permlane16_swap_b32 v46, v47
    s_nop 1
    v_max_f32 v46, v46, v47
    v_mul_f32 v46, s84, v46
    v_max_f32 v46, v46, v44
    v_sub_f32 v47, v44, v46
    v_cmp_neq_f32 vcc, v44, v46
    v_exp_f32 v48, v47
    v_mov_b32 v44, v46
    v_fma_f32 v32, v32, s84, -v44
    v_fma_f32 v33, v33, s84, -v44
    v_fma_f32 v34, v34, s84, -v44
    v_fma_f32 v35, v35, s84, -v44
    v_exp_f32 v32, v32
    v_exp_f32 v33, v33
    v_exp_f32 v34, v34
    v_exp_f32 v35, v35
    s_cbranch_vccz L_nr13
    v_mov_b32 v49, v48
    v_mul_f32 v45, v45, v48
    v_pk_mul_f32 v[64:65], v[64:65], v[48:49]
    v_pk_mul_f32 v[66:67], v[66:67], v[48:49]
    v_pk_mul_f32 v[68:69], v[68:69], v[48:49]
    v_pk_mul_f32 v[70:71], v[70:71], v[48:49]
    v_pk_mul_f32 v[72:73], v[72:73], v[48:49]
    v_pk_mul_f32 v[74:75], v[74:75], v[48:49]
    v_pk_mul_f32 v[76:77], v[76:77], v[48:49]
    v_pk_mul_f32 v[78:79], v[78:79], v[48:49]
    v_pk_mul_f32 v[80:81], v[80:81], v[48:49]
    v_pk_mul_f32 v[82:83], v[82:83], v[48:49]
    v_pk_mul_f32 v[84:85], v[84:85], v[48:49]
    v_pk_mul_f32 v[86:87], v[86:87], v[48:49]
    v_pk_mul_f32 v[88:89], v[88:89], v[48:49]
    v_pk_mul_f32 v[90:91], v[90:91], v[48:49]
    v_pk_mul_f32 v[92:93], v[92:93], v[48:49]
    v_pk_mul_f32 v[94:95], v[94:95], v[48:49]
    v_pk_mul_f32 v[96:97], v[96:97], v[48:49]
    v_pk_mul_f32 v[98:99], v[98:99], v[48:49]
    v_pk_mul_f32 v[100:101], v[100:101], v[48:49]
    v_pk_mul_f32 v[102:103], v[102:103], v[48:49]
    v_pk_mul_f32 v[104:105], v[104:105], v[48:49]
    v_pk_mul_f32 v[106:107], v[106:107], v[48:49]
    v_pk_mul_f32 v[108:109], v[108:109], v[48:49]
    v_pk_mul_f32 v[110:111], v[110:111], v[48:49]
    v_pk_mul_f32 v[112:113], v[112:113], v[48:49]
    v_pk_mul_f32 v[114:115], v[114:115], v[48:49]
    v_pk_mul_f32 v[116:117], v[116:117], v[48:49]
    v_pk_mul_f32 v[118:119], v[118:119], v[48:49]
    v_pk_mul_f32 v[120:121], v[120:121], v[48:49]
    v_pk_mul_f32 v[122:123], v[122:123], v[48:49]
    v_pk_mul_f32 v[124:125], v[124:125], v[48:49]
    v_pk_mul_f32 v[126:127], v[126:127], v[48:49]
L_nr13:
    v_add_f32 v46, v32, v33
    v_add_f32 v48, v34, v35
    v_cvt_pk_bf16_f32 v40, v32, v33
    v_cvt_pk_bf16_f32 v41, v34, v35
    v_add_f32 v45, v45, v46
    v_add_f32 v45, v45, v48
    s_waitcnt vmcnt(8)
    ds_read_b64_tr_b16 v[128:129], v24 offset:0
    ds_read_b64_tr_b16 v[132:133], v25 offset:0
    ds_read_b64_tr_b16 v[136:137], v26 offset:0
    ds_read_b64_tr_b16 v[140:141], v27 offset:0
    ds_read_b64_tr_b16 v[144:145], v28 offset:0
    ds_read_b64_tr_b16 v[148:149], v29 offset:0
    ds_read_b64_tr_b16 v[152:153], v30 offset:0
    ds_read_b64_tr_b16 v[156:157], v31 offset:0
    ds_read_b64_tr_b16 v[160:161], v24 offset:256
    ds_read_b64_tr_b16 v[164:165], v25 offset:256
    ds_read_b64_tr_b16 v[168:169], v26 offset:256
    ds_read_b64_tr_b16 v[172:173], v27 offset:256
    ds_read_b64_tr_b16 v[176:177], v28 offset:256
    ds_read_b64_tr_b16 v[180:181], v29 offset:256
    ds_read_b64_tr_b16 v[184:185], v30 offset:256
    ds_read_b64_tr_b16 v[188:189], v31 offset:256
    s_waitcnt lgkmcnt(0)
    s_mov_b64 exec, 1
    v_mov_b32 v60, 1
    buffer_atomic_add v60, v61, s[68:71], 0 offen sc0 sc1
    s_mov_b64 exec, -1
    s_waitcnt vmcnt(10)
    s_add_u32 s83, s81, 0
    s_add_u32 m0, s79, 16384
    s_nop 0
    buffer_load_dwordx4 v16, s[32:35], s83 offen offset:0 nt lds
    buffer_load_dwordx4 v17, s[32:35], s83 offen offset:1024 nt lds
    s_waitcnt vmcnt(10)
    buffer_load_dwordx4 v18, s[32:35], s83 offen offset:2048 nt lds
    buffer_load_dwordx4 v19, s[32:35], s83 offen offset:3072 nt lds
    s_waitcnt vmcnt(10)
    s_add_u32 s83, s81, 4096
    s_add_u32 m0, s79, 20480
    s_nop 0
    buffer_load_dwordx4 v16, s[32:35], s83 offen offset:0 nt lds
    buffer_load_dwordx4 v17, s[32:35], s83 offen offset:1024 nt lds
    s_waitcnt vmcnt(10)
    buffer_load_dwordx4 v18, s[32:35], s83 offen offset:2048 nt lds
    buffer_load_dwordx4 v19, s[32:35], s83 offen offset:3072 nt lds
    v_mfma_f32_16x16x16_bf16 v[64:67], v[128:129], v[40:41], v[64:67]
    v_mfma_f32_16x16x16_bf16 v[68:71], v[132:133], v[40:41], v[68:71]
    v_mfma_f32_16x16x16_bf16 v[72:75], v[136:137], v[40:41], v[72:75]
    v_mfma_f32_16x16x16_bf16 v[76:79], v[140:141], v[40:41], v[76:79]
    v_mfma_f32_16x16x16_bf16 v[80:83], v[144:145], v[40:41], v[80:83]
    v_mfma_f32_16x16x16_bf16 v[84:87], v[148:149], v[40:41], v[84:87]
    v_mfma_f32_16x16x16_bf16 v[88:91], v[152:153], v[40:41], v[88:91]
    v_mfma_f32_16x16x16_bf16 v[92:95], v[156:157], v[40:41], v[92:95]
    v_mfma_f32_16x16x16_bf16 v[96:99], v[160:161], v[40:41], v[96:99]
    v_mfma_f32_16x16x16_bf16 v[100:103], v[164:165], v[40:41], v[100:103]
    v_mfma_f32_16x16x16_bf16 v[104:107], v[168:169], v[40:41], v[104:107]
    v_mfma_f32_16x16x16_bf16 v[108:111], v[172:173], v[40:41], v[108:111]
    v_mfma_f32_16x16x16_bf16 v[112:115], v[176:177], v[40:41], v[112:115]
    v_mfma_f32_16x16x16_bf16 v[116:119], v[180:181], v[40:41], v[116:119]
    v_mfma_f32_16x16x16_bf16 v[120:123], v[184:185], v[40:41], v[120:123]
    v_mfma_f32_16x16x16_bf16 v[124:127], v[188:189], v[40:41], v[124:127]
    s_waitcnt vmcnt(8)
    v_readfirstlane_b32 s80, v60
    s_add_u32 s80, s80, 176
    s_cmp_lt_u32 s80, 272
    s_cbranch_scc1 L_half
L_hl:
    v_mov_b32 v47, 155876
    v_mov_b32 v46, 1
    ds_write_b32 v47, v46
    v_mov_b32 v47, 155844
    s_mov_b32 s96, 0
L_sp14:
    ds_read_b32 v46, v47
    s_waitcnt lgkmcnt(0)
    v_readfirstlane_b32 s95, v46
    s_cmp_ge_u32 s95, 1
    s_cbranch_scc1 L_sd15
    s_sleep 1
    s_add_u32 s96, s96, 1
    s_cmp_lt_u32 s96, 2097152
    s_cbranch_scc1 L_sp14
L_sd15:
    v_mov_b32 v46, 155852
    v_mov_b32 v47, 1
    s_mov_b64 exec, 1
    ds_add_u32 v46, v47
    s_mov_b64 exec, -1
    s_waitcnt vmcnt(8)
    ds_read_b128 v[128:131], v20 offset:0
    ds_read_b128 v[132:135], v21 offset:0
    ds_read_b128 v[136:139], v22 offset:0
    ds_read_b128 v[140:143], v23 offset:0
    ds_read_b128 v[144:147], v20 offset:256
    ds_read_b128 v[148:151], v21 offset:256
    ds_read_b128 v[152:155], v22 offset:256
    ds_read_b128 v[156:159], v23 offset:256
    s_waitcnt lgkmcnt(0)
    v_mfma_f32_16x16x32_bf16 v[32:35], v[128:131], v[192:195], 0
    v_mfma_f32_16x16x32_bf16 v[32:35], v[132:135], v[196:199], v[32:35]
    v_mfma_f32_16x16x32_bf16 v[32:35], v[136:139], v[200:203], v[32:35]
    v_mfma_f32_16x16x32_bf16 v[32:35], v[140:143], v[204:207], v[32:35]
    v_mfma_f32_16x16x32_bf16 v[32:35], v[144:147], v[208:211], v[32:35]
    v_mfma_f32_16x16x32_bf16 v[32:35], v[148:151], v[212:215], v[32:35]
    v_mfma_f32_16x16x32_bf16 v[32:35], v[152:155], v[216:219], v[32:35]
    v_mfma_f32_16x16x32_bf16 v[32:35], v[156:159], v[220:223], v[32:35]
    s_nop 7
    v_cvt_pk_bf16_f32 v40, v32, v33
    v_cvt_pk_bf16_f32 v41, v34, v35
    v_lshlrev_b32 v32, 16, v40
    v_and_b32 v33, 0xffff0000, v40
    v_lshlrev_b32 v34, 16, v41
    v_and_b32 v35, 0xffff0000, v41
    v_max3_f32 v46, v32, v33, v34
    v_max_f32 v46, v46, v35
    v_mov_b32 v47, v46
    s_nop 1
    v_permlane32_swap_b32 v46, v47
    s_nop 1
    v_max_f32 v46, v46, v47
    v_mov_b32 v47, v46
    s_nop 1
    v_permlane16_swap_b32 v46, v47
    s_nop 1
    v_max_f32 v46, v46, v47
    v_mul_f32 v46, s84, v46
    v_max_f32 v46, v46, v44
    v_sub_f32 v47, v44, v46
    v_cmp_neq_f32 vcc, v44, v46
    v_exp_f32 v48, v47
    v_mov_b32 v44, v46
    v_fma_f32 v32, v32, s84, -v44
    v_fma_f32 v33, v33, s84, -v44
    v_fma_f32 v34, v34, s84, -v44
    v_fma_f32 v35, v35, s84, -v44
    v_exp_f32 v32, v32
    v_exp_f32 v33, v33
    v_exp_f32 v34, v34
    v_exp_f32 v35, v35
    s_cbranch_vccz L_nr16
    v_mov_b32 v49, v48
    v_mul_f32 v45, v45, v48
    v_pk_mul_f32 v[64:65], v[64:65], v[48:49]
    v_pk_mul_f32 v[66:67], v[66:67], v[48:49]
    v_pk_mul_f32 v[68:69], v[68:69], v[48:49]
    v_pk_mul_f32 v[70:71], v[70:71], v[48:49]
    v_pk_mul_f32 v[72:73], v[72:73], v[48:49]
    v_pk_mul_f32 v[74:75], v[74:75], v[48:49]
    v_pk_mul_f32 v[76:77], v[76:77], v[48:49]
    v_pk_mul_f32 v[78:79], v[78:79], v[48:49]
    v_pk_mul_f32 v[80:81], v[80:81], v[48:49]
    v_pk_mul_f32 v[82:83], v[82:83], v[48:49]
    v_pk_mul_f32 v[84:85], v[84:85], v[48:49]
    v_pk_mul_f32 v[86:87], v[86:87], v[48:49]
    v_pk_mul_f32 v[88:89], v[88:89], v[48:49]
    v_pk_mul_f32 v[90:91], v[90:91], v[48:49]
    v_pk_mul_f32 v[92:93], v[92:93], v[48:49]
    v_pk_mul_f32 v[94:95], v[94:95], v[48:49]
    v_pk_mul_f32 v[96:97], v[96:97], v[48:49]
    v_pk_mul_f32 v[98:99], v[98:99], v[48:49]
    v_pk_mul_f32 v[100:101], v[100:101], v[48:49]
    v_pk_mul_f32 v[102:103], v[102:103], v[48:49]
    v_pk_mul_f32 v[104:105], v[104:105], v[48:49]
    v_pk_mul_f32 v[106:107], v[106:107], v[48:49]
    v_pk_mul_f32 v[108:109], v[108:109], v[48:49]
    v_pk_mul_f32 v[110:111], v[110:111], v[48:49]
    v_pk_mul_f32 v[112:113], v[112:113], v[48:49]
    v_pk_mul_f32 v[114:115], v[114:115], v[48:49]
    v_pk_mul_f32 v[116:117], v[116:117], v[48:49]
    v_pk_mul_f32 v[118:119], v[118:119], v[48:49]
    v_pk_mul_f32 v[120:121], v[120:121], v[48:49]
    v_pk_mul_f32 v[122:123], v[122:123], v[48:49]
    v_pk_mul_f32 v[124:125], v[124:125], v[48:49]
    v_pk_mul_f32 v[126:127], v[126:127], v[48:49]
L_nr16:
    v_add_f32 v46, v32, v33
    v_add_f32 v48, v34, v35
    v_cvt_pk_bf16_f32 v40, v32, v33
    v_cvt_pk_bf16_f32 v41, v34, v35
    v_add_f32 v45, v45, v46
    v_add_f32 v45, v45, v48
    v_mov_b32 v46, v45
    s_nop 1
    v_permlane32_swap_b32 v45, v46
    s_nop 1
    v_add_f32 v45, v45, v46
    v_mov_b32 v46, v45
    s_nop 1
    v_permlane16_swap_b32 v45, v46
    s_nop 1
    v_add_f32 v45, v45, v46
    v_lshlrev_b32 v46, 10, v6
    v_lshl_add_u32 v46, v7, 4, v46
    v_add_u32 v46, s79, v46
    s_lshl_b32 s86, s74, 4
    s_add_u32 s86, s86, 155904
    v_lshl_add_u32 v47, v0, 2, s86
    s_mov_b64 exec, 3
    ds_write2_b32 v47, v44, v45 offset0:0 offset1:2
    s_mov_b64 exec, -1
    s_waitcnt vmcnt(0)
    ds_read_b64_tr_b16 v[128:129], v24 offset:0
    ds_read_b64_tr_b16 v[132:133], v25 offset:0
    ds_read_b64_tr_b16 v[136:137], v26 offset:0
    ds_read_b64_tr_b16 v[140:141], v27 offset:0
    ds_read_b64_tr_b16 v[144:145], v28 offset:0
    ds_read_b64_tr_b16 v[148:149], v29 offset:0
    ds_read_b64_tr_b16 v[152:153], v30 offset:0
    ds_read_b64_tr_b16 v[156:157], v31 offset:0
    ds_read_b64_tr_b16 v[160:161], v24 offset:256
    ds_read_b64_tr_b16 v[164:165], v25 offset:256
    ds_read_b64_tr_b16 v[168:169], v26 offset:256
    ds_read_b64_tr_b16 v[172:173], v27 offset:256
    ds_read_b64_tr_b16 v[176:177], v28 offset:256
    ds_read_b64_tr_b16 v[180:181], v29 offset:256
    ds_read_b64_tr_b16 v[184:185], v30 offset:256
    ds_read_b64_tr_b16 v[188:189], v31 offset:256
    s_waitcnt vmcnt(0)
    s_waitcnt lgkmcnt(15)
    v_mfma_f32_16x16x16_bf16 v[64:67], v[128:129], v[40:41], v[64:67]
    s_waitcnt lgkmcnt(14)
    v_mfma_f32_16x16x16_bf16 v[68:71], v[132:133], v[40:41], v[68:71]
    s_waitcnt lgkmcnt(13)
    v_mfma_f32_16x16x16_bf16 v[72:75], v[136:137], v[40:41], v[72:75]
    s_waitcnt lgkmcnt(12)
    v_mfma_f32_16x16x16_bf16 v[76:79], v[140:141], v[40:41], v[76:79]
    s_waitcnt lgkmcnt(11)
    v_mfma_f32_16x16x16_bf16 v[80:83], v[144:145], v[40:41], v[80:83]
    s_waitcnt lgkmcnt(10)
    v_mfma_f32_16x16x16_bf16 v[84:87], v[148:149], v[40:41], v[84:87]
    s_waitcnt lgkmcnt(9)
    v_mfma_f32_16x16x16_bf16 v[88:91], v[152:153], v[40:41], v[88:91]
    s_waitcnt lgkmcnt(8)
    v_mfma_f32_16x16x16_bf16 v[92:95], v[156:157], v[40:41], v[92:95]
    s_waitcnt lgkmcnt(7)
    v_mfma_f32_16x16x16_bf16 v[96:99], v[160:161], v[40:41], v[96:99]
    s_waitcnt lgkmcnt(6)
    v_mfma_f32_16x16x16_bf16 v[100:103], v[164:165], v[40:41], v[100:103]
    s_waitcnt lgkmcnt(5)
    v_mfma_f32_16x16x16_bf16 v[104:107], v[168:169], v[40:41], v[104:107]
    s_waitcnt lgkmcnt(4)
    v_mfma_f32_16x16x16_bf16 v[108:111], v[172:173], v[40:41], v[108:111]
    s_waitcnt lgkmcnt(3)
    v_mfma_f32_16x16x16_bf16 v[112:115], v[176:177], v[40:41], v[112:115]
    s_waitcnt lgkmcnt(2)
    v_mfma_f32_16x16x16_bf16 v[116:119], v[180:181], v[40:41], v[116:119]
    s_waitcnt lgkmcnt(1)
    v_mfma_f32_16x16x16_bf16 v[120:123], v[184:185], v[40:41], v[120:123]
    s_waitcnt lgkmcnt(0)
    v_mfma_f32_16x16x16_bf16 v[124:127], v[188:189], v[40:41], v[124:127]
L_merge:
    s_mov_b32 exec_lo, 0x00030003
    s_mov_b32 exec_hi, 0x00030003
    ds_write_b128 v46, v[64:67] offset:0
    ds_write_b128 v46, v[68:71] offset:64
    ds_write_b128 v46, v[72:75] offset:128
    ds_write_b128 v46, v[76:79] offset:192
    ds_write_b128 v46, v[80:83] offset:256
    ds_write_b128 v46, v[84:87] offset:320
    ds_write_b128 v46, v[88:91] offset:384
    ds_write_b128 v46, v[92:95] offset:448
    ds_write_b128 v46, v[96:99] offset:512
    ds_write_b128 v46, v[100:103] offset:576
    ds_write_b128 v46, v[104:107] offset:640
    ds_write_b128 v46, v[108:111] offset:704
    ds_write_b128 v46, v[112:115] offset:768
    ds_write_b128 v46, v[116:119] offset:832
    ds_write_b128 v46, v[120:123] offset:896
    ds_write_b128 v46, v[124:127] offset:960
    s_mov_b64 exec, -1
    v_mov_b32 v50, 155848
    v_mov_b32 v49, 1
    v_lshlrev_b32 v46, 5, v0
    v_lshlrev_b32 v47, 2, v4
    v_add_u32 v47, 155904, v47
    v_add_u32 v48, 0x10000, v46
    s_mov_b64 exec, 1
    ds_add_rtn_u32 v49, v50, v49
    s_mov_b64 exec, -1
    ds_read2_b32 v[32:33], v47 offset0:0 offset1:2
    ds_read2_b32 v[34:35], v47 offset0:4 offset1:6
    ds_read2_b32 v[36:37], v47 offset0:8 offset1:10
    ds_read2_b32 v[38:39], v47 offset0:12 offset1:14
    ds_read_b128 v[128:131], v46 offset:0
    ds_read_b128 v[132:135], v46 offset:16
    ds_read_b128 v[136:139], v46 offset:32768
    ds_read_b128 v[140:143], v46 offset:32784
    ds_read_b128 v[144:147], v48 offset:0
    ds_read_b128 v[148:151], v48 offset:16
    ds_read_b128 v[152:155], v48 offset:32768
    ds_read_b128 v[156:159], v48 offset:32784
    s_waitcnt lgkmcnt(12)
    v_readfirstlane_b32 s95, v49
    s_cmp_lg_u32 s95, 3
    s_cbranch_scc1 L_end
    s_waitcnt lgkmcnt(8)
    v_max3_f32 v44, v32, v34, v36
    v_max_f32 v44, v44, v38
    v_sub_f32 v32, v32, v44
    v_sub_f32 v34, v34, v44
    v_sub_f32 v36, v36, v44
    v_sub_f32 v38, v38, v44
    v_exp_f32 v32, v32
    v_exp_f32 v34, v34
    v_exp_f32 v36, v36
    v_exp_f32 v38, v38
    s_nop 0
    v_mul_f32 v45, v32, v33
    v_fmac_f32 v45, v34, v35
    v_fmac_f32 v45, v36, v37
    v_fmac_f32 v45, v38, v39
    v_rcp_f32 v46, v45
    s_nop 0
    v_mul_f32 v32, v32, v46
    v_mul_f32 v34, v34, v46
    v_mul_f32 v36, v36, v46
    v_mul_f32 v38, v38, v46
    s_waitcnt lgkmcnt(0)
    v_mul_f32 v128, v128, v32
    v_mul_f32 v129, v129, v32
    v_mul_f32 v130, v130, v32
    v_mul_f32 v131, v131, v32
    v_mul_f32 v132, v132, v32
    v_mul_f32 v133, v133, v32
    v_mul_f32 v134, v134, v32
    v_mul_f32 v135, v135, v32
    v_fmac_f32 v128, v136, v34
    v_fmac_f32 v129, v137, v34
    v_fmac_f32 v130, v138, v34
    v_fmac_f32 v131, v139, v34
    v_fmac_f32 v132, v140, v34
    v_fmac_f32 v133, v141, v34
    v_fmac_f32 v134, v142, v34
    v_fmac_f32 v135, v143, v34
    v_fmac_f32 v128, v144, v36
    v_fmac_f32 v129, v145, v36
    v_fmac_f32 v130, v146, v36
    v_fmac_f32 v131, v147, v36
    v_fmac_f32 v132, v148, v36
    v_fmac_f32 v133, v149, v36
    v_fmac_f32 v134, v150, v36
    v_fmac_f32 v135, v151, v36
    v_fmac_f32 v128, v152, v38
    v_fmac_f32 v129, v153, v38
    v_fmac_f32 v130, v154, v38
    v_fmac_f32 v131, v155, v38
    v_fmac_f32 v132, v156, v38
    v_fmac_f32 v133, v157, v38
    v_fmac_f32 v134, v158, v38
    v_fmac_f32 v135, v159, v38
    v_cvt_pk_bf16_f32 v40, v128, v129
    v_cvt_pk_bf16_f32 v41, v130, v131
    v_cvt_pk_bf16_f32 v42, v132, v133
    v_cvt_pk_bf16_f32 v43, v134, v135
    v_min_u32 v40, -2, v40
    v_min_u32 v41, -2, v41
    v_min_u32 v42, -2, v42
    v_min_u32 v43, -2, v43
    v_min_u32 v44, -2, v44
    v_min_u32 v45, -2, v45
    buffer_store_dwordx4 v[40:43], v2, s[68:71], 0 offen sc1
    s_mov_b32 exec_lo, 0x10001
    s_mov_b32 exec_hi, 0x10001
    buffer_store_dwordx2 v[44:45], v2, s[68:71], 0 offen offset:256 sc1
    s_mov_b64 exec, -1
    s_endpgm
L_side:
    s_sub_u32 s74, s74, 4
    s_setprio 3
    s_mul_i32 s78, s74, 1792
    v_lshlrev_b32 v8, 4, v0
    v_mov_b32 v16, 0
    v_mov_b32 v17, 0
    v_mov_b32 v18, 0
    v_mov_b32 v19, 0
    v_mov_b32 v20, 0
    v_mov_b32 v21, 0
    v_mov_b32 v22, 0
    v_mov_b32 v23, 0
    v_lshrrev_b32 v14, 3, v0
    v_and_b32 v15, 7, v0
    v_lshlrev_b32 v15, 4, v15
    s_waitcnt lgkmcnt(0)
    s_mov_b32 s36, s4
    s_mov_b32 s37, s5
    s_mov_b32 s38, 7168
    s_mov_b32 s39, 0x20000
    s_mov_b32 s40, s10
    s_mov_b32 s41, s11
    s_mov_b32 s42, 3670016
    s_mov_b32 s43, 0x20000
    s_cmp_eq_u32 s3, 0
    s_cbranch_scc1 L_nox
    s_mov_b32 exec_hi, 0x00ffffff
    buffer_load_dwordx4 v[16:19], v8, s[36:39], s78 offen
    buffer_load_dwordx4 v[20:23], v8, s[36:39], s78 offen offset:896
    s_mov_b64 exec, -1
    s_cmp_lg_u32 s3, 1
    s_cbranch_scc1 L_nox
    s_lshr_b32 s79, s72, 2
    s_xor_b32 s79, s79, s73
    s_and_b32 s79, s79, 1
    s_lshl1_add_u32 s79, s72, s79
    s_lshr_b32 s80, s73, 4
    s_lshl1_add_u32 s79, s79, s80
    s_bfe_u32 s80, s73, 0x10001
    s_lshl1_add_u32 s79, s79, s80
    s_lshl_b32 s80, s79, 7
    v_lshl_add_u32 v9, v14, 13, v15
    v_add_u32 v9, s80, v9
    s_lshl_b32 s80, s74, 18
    s_lshl_b32 s81, s74, 15
    s_add_u32 m0, s81, 16384
    s_add_u32 s82, s80, 0
    buffer_load_dwordx4 v9, s[40:43], s82 offen nt lds
    s_add_u32 m0, s81, 17408
    s_add_u32 s82, s80, 65536
    buffer_load_dwordx4 v9, s[40:43], s82 offen nt lds
    s_add_u32 m0, s81, 18432
    s_add_u32 s82, s80, 131072
    buffer_load_dwordx4 v9, s[40:43], s82 offen nt lds
    s_add_u32 m0, s81, 19456
    s_add_u32 s82, s80, 196608
    buffer_load_dwordx4 v9, s[40:43], s82 offen nt lds
    s_add_u32 m0, s81, 20480
    s_add_u32 s82, s80, 1048576
    buffer_load_dwordx4 v9, s[40:43], s82 offen nt lds
    s_add_u32 m0, s81, 21504
    s_add_u32 s82, s80, 1114112
    buffer_load_dwordx4 v9, s[40:43], s82 offen nt lds
    s_add_u32 m0, s81, 22528
    s_add_u32 s82, s80, 1179648
    buffer_load_dwordx4 v9, s[40:43], s82 offen nt lds
    s_add_u32 m0, s81, 23552
    s_add_u32 s82, s80, 1245184
    buffer_load_dwordx4 v9, s[40:43], s82 offen nt lds
    s_add_u32 m0, s81, 24576
    s_add_u32 s82, s80, 2097152
    buffer_load_dwordx4 v9, s[40:43], s82 offen nt lds
    s_add_u32 m0, s81, 25600
    s_add_u32 s82, s80, 2162688
    buffer_load_dwordx4 v9, s[40:43], s82 offen nt lds
    s_add_u32 m0, s81, 26624
    s_add_u32 s82, s80, 2228224
    buffer_load_dwordx4 v9, s[40:43], s82 offen nt lds
    s_add_u32 m0, s81, 27648
    s_add_u32 s82, s80, 2293760
    buffer_load_dwordx4 v9, s[40:43], s82 offen nt lds
    s_cmp_ge_u32 s74, 2
    s_cbranch_scc1 L_nox
    s_add_u32 m0, s81, 28672
    s_add_u32 s82, s80, 3145728
    buffer_load_dwordx4 v9, s[40:43], s82 offen nt lds
    s_add_u32 m0, s81, 29696
    s_add_u32 s82, s80, 3211264
    buffer_load_dwordx4 v9, s[40:43], s82 offen nt lds
    s_add_u32 m0, s81, 30720
    s_add_u32 s82, s80, 3276800
    buffer_load_dwordx4 v9, s[40:43], s82 offen nt lds
    s_add_u32 m0, s81, 31744
    s_add_u32 s82, s80, 3342336
    buffer_load_dwordx4 v9, s[40:43], s82 offen nt lds
L_nox:
    v_mov_b32 v10, 0
    v_lshlrev_b32 v11, 2, v6
    v_add_u32 v11, 155840, v11
    ds_write_b32 v11, v10
    s_waitcnt lgkmcnt(0)
    s_barrier
    s_load_dwordx2 s[4:5], s[26:27], 491520
    s_mov_b32 s44, s12
    s_mov_b32 s45, s13
    s_mov_b32 s46, 3670016
    s_mov_b32 s47, 0x20000
    s_mov_b32 s48, s16
    s_mov_b32 s49, s17
    s_mov_b32 s50, 1605632
    s_mov_b32 s51, 0x20000
    s_mov_b32 s52, s18
    s_mov_b32 s53, s19
    s_mov_b32 s54, 1605632
    s_mov_b32 s55, 0x20000
    s_mov_b32 s56, s20
    s_mov_b32 s57, s21
    s_mov_b32 s58, 1605632
    s_mov_b32 s59, 0x20000
    s_mov_b32 s60, s22
    s_mov_b32 s61, s23
    s_mov_b32 s62, 7168
    s_mov_b32 s63, 0x20000
    s_mov_b32 s68, s26
    s_mov_b32 s69, s27
    s_mov_b32 s70, 2097152
    s_mov_b32 s71, 0x20000
    v_lshrrev_b32 v12, 2, v6
    v_lshl_add_u32 v12, v7, 3, v12
    v_and_b32 v13, 3, v0
    v_lshlrev_b32 v13, 3, v13
    v_lshl_add_u32 v63, v12, 7, v13
    v_lshl_add_u32 v12, v12, 5, v13
    v_and_b32 v13, 7, v0
    v_mul_u32_u24 v13, 912, v13
    v_lshl_add_u32 v13, v7, 4, v13
    v_add_u32 v13, 147456, v13
    s_lshl_b32 s81, s74, 12
    s_add_u32 s81, s81, 131072
    v_add_u32 v12, s81, v12
    s_cmp_eq_u32 s3, 0
    s_cbranch_scc1 L_noln
    s_cmp_eq_u32 s3, 1
    s_cbranch_scc1 L_x1
    s_waitcnt vmcnt(0)
    s_branch L_x2
L_x1:
    s_and_b32 s80, s79, 7
    s_lshl_b32 s80, s80, 3
    s_lshr_b32 s82, s79, 3
    s_add_u32 s80, s80, s82
    s_lshl_b32 s80, s80, 8
    s_add_u32 s80, s80, 458752
    v_mov_b32 v11, s80
    s_cmp_lg_u32 s74, 3
    s_cbranch_scc1 L_x3
    s_mov_b64 exec, 1
    buffer_store_dword v10, v11, s[68:71], 0 offen sc1
    s_mov_b64 exec, -1
    s_waitcnt vmcnt(13)
    s_branch L_x2
L_x3:
    s_waitcnt vmcnt(12)
L_x2:
    v_lshlrev_b32 v24, 16, v16
    v_and_b32 v25, 0xffff0000, v16
    v_lshlrev_b32 v26, 16, v17
    v_and_b32 v27, 0xffff0000, v17
    v_lshlrev_b32 v28, 16, v18
    v_and_b32 v29, 0xffff0000, v18
    v_lshlrev_b32 v30, 16, v19
    v_and_b32 v31, 0xffff0000, v19
    v_lshlrev_b32 v32, 16, v20
    v_and_b32 v33, 0xffff0000, v20
    v_lshlrev_b32 v34, 16, v21
    v_and_b32 v35, 0xffff0000, v21
    v_lshlrev_b32 v36, 16, v22
    v_and_b32 v37, 0xffff0000, v22
    v_lshlrev_b32 v38, 16, v23
    v_and_b32 v39, 0xffff0000, v23
    v_add_f32 v40, v24, v25
    v_add_f32 v40, v40, v26
    v_add_f32 v40, v40, v27
    v_add_f32 v40, v40, v28
    v_add_f32 v40, v40, v29
    v_add_f32 v40, v40, v30
    v_add_f32 v40, v40, v31
    v_add_f32 v41, v32, v33
    v_add_f32 v41, v41, v34
    v_add_f32 v41, v41, v35
    v_add_f32 v41, v41, v36
    v_add_f32 v41, v41, v37
    v_add_f32 v41, v41, v38
    v_add_f32 v41, v41, v39
    s_nop 1
    v_add_f32_dpp v40, v40, v40 quad_perm:[1,0,3,2] row_mask:0xf bank_mask:0xf
    v_add_f32_dpp v41, v41, v41 quad_perm:[1,0,3,2] row_mask:0xf bank_mask:0xf
    s_nop 1
    v_add_f32_dpp v40, v40, v40 quad_perm:[2,3,0,1] row_mask:0xf bank_mask:0xf
    v_add_f32_dpp v41, v41, v41 quad_perm:[2,3,0,1] row_mask:0xf bank_mask:0xf
    s_nop 1
    v_add_f32_dpp v40, v40, v40 row_half_mirror row_mask:0xf bank_mask:0xf
    v_add_f32_dpp v41, v41, v41 row_half_mirror row_mask:0xf bank_mask:0xf
    s_nop 1
    v_add_f32_dpp v40, v40, v40 row_mirror row_mask:0xf bank_mask:0xf
    v_add_f32_dpp v41, v41, v41 row_mirror row_mask:0xf bank_mask:0xf
    v_mov_b32 v42, v40
    v_mov_b32 v43, v41
    s_nop 1
    v_permlane32_swap_b32 v40, v42
    v_permlane32_swap_b32 v41, v43
    s_nop 1
    v_add_f32 v40, v40, v42
    v_add_f32 v41, v41, v43
    v_mov_b32 v42, v40
    v_mov_b32 v43, v41
    s_nop 1
    v_permlane16_swap_b32 v40, v42
    v_permlane16_swap_b32 v41, v43
    s_nop 1
    v_add_f32 v40, v40, v42
    v_add_f32 v41, v41, v43
    s_mov_b32 s83, 0x3b124925
    v_mul_f32 v40, s83, v40
    v_mov_b32 v44, 0
    v_mul_f32 v41, s83, v41
    v_mov_b32 v45, 0
    s_mov_b32 exec_hi, 0x00ffffff
    v_sub_f32 v42, v24, v40
    v_sub_f32 v43, v32, v41
    v_fmac_f32 v44, v42, v42
    v_fmac_f32 v45, v43, v43
    v_sub_f32 v42, v25, v40
    v_sub_f32 v43, v33, v41
    v_fmac_f32 v44, v42, v42
    v_fmac_f32 v45, v43, v43
    v_sub_f32 v42, v26, v40
    v_sub_f32 v43, v34, v41
    v_fmac_f32 v44, v42, v42
    v_fmac_f32 v45, v43, v43
    v_sub_f32 v42, v27, v40
    v_sub_f32 v43, v35, v41
    v_fmac_f32 v44, v42, v42
    v_fmac_f32 v45, v43, v43
    v_sub_f32 v42, v28, v40
    v_sub_f32 v43, v36, v41
    v_fmac_f32 v44, v42, v42
    v_fmac_f32 v45, v43, v43
    v_sub_f32 v42, v29, v40
    v_sub_f32 v43, v37, v41
    v_fmac_f32 v44, v42, v42
    v_fmac_f32 v45, v43, v43
    v_sub_f32 v42, v30, v40
    v_sub_f32 v43, v38, v41
    v_fmac_f32 v44, v42, v42
    v_fmac_f32 v45, v43, v43
    v_sub_f32 v42, v31, v40
    v_sub_f32 v43, v39, v41
    v_fmac_f32 v44, v42, v42
    v_fmac_f32 v45, v43, v43
    s_mov_b64 exec, -1
    s_nop 1
    v_add_f32_dpp v44, v44, v44 quad_perm:[1,0,3,2] row_mask:0xf bank_mask:0xf
    v_add_f32_dpp v45, v45, v45 quad_perm:[1,0,3,2] row_mask:0xf bank_mask:0xf
    s_nop 1
    v_add_f32_dpp v44, v44, v44 quad_perm:[2,3,0,1] row_mask:0xf bank_mask:0xf
    v_add_f32_dpp v45, v45, v45 quad_perm:[2,3,0,1] row_mask:0xf bank_mask:0xf
    s_nop 1
    v_add_f32_dpp v44, v44, v44 row_half_mirror row_mask:0xf bank_mask:0xf
    v_add_f32_dpp v45, v45, v45 row_half_mirror row_mask:0xf bank_mask:0xf
    s_nop 1
    v_add_f32_dpp v44, v44, v44 row_mirror row_mask:0xf bank_mask:0xf
    v_add_f32_dpp v45, v45, v45 row_mirror row_mask:0xf bank_mask:0xf
    v_mov_b32 v42, v44
    v_mov_b32 v43, v45
    s_nop 1
    v_permlane32_swap_b32 v44, v42
    v_permlane32_swap_b32 v45, v43
    s_nop 1
    v_add_f32 v44, v44, v42
    v_add_f32 v45, v45, v43
    v_mov_b32 v42, v44
    v_mov_b32 v43, v45
    s_nop 1
    v_permlane16_swap_b32 v44, v42
    v_permlane16_swap_b32 v45, v43
    s_nop 1
    v_add_f32 v44, v44, v42
    v_add_f32 v45, v45, v43
    v_mul_f32 v44, s83, v44
    v_cvt_pk_bf16_f32 v44, v44, v44
    v_and_b32 v44, 0xffff0000, v44
    v_add_f32 v44, 0x3727c5ac, v44
    v_cvt_pk_bf16_f32 v44, v44, v44
    v_and_b32 v44, 0xffff0000, v44
    v_sqrt_f32 v44, v44
    v_cvt_pk_bf16_f32 v40, v40, v40
    v_and_b32 v40, 0xffff0000, v40
    v_cvt_pk_bf16_f32 v44, v44, v44
    v_and_b32 v44, 0xffff0000, v44
    v_rcp_f32 v44, v44
    v_mul_f32 v45, s83, v45
    v_cvt_pk_bf16_f32 v45, v45, v45
    v_and_b32 v45, 0xffff0000, v45
    v_add_f32 v45, 0x3727c5ac, v45
    v_cvt_pk_bf16_f32 v45, v45, v45
    v_and_b32 v45, 0xffff0000, v45
    v_sqrt_f32 v45, v45
    v_cvt_pk_bf16_f32 v41, v41, v41
    v_and_b32 v41, 0xffff0000, v41
    v_cvt_pk_bf16_f32 v45, v45, v45
    v_and_b32 v45, 0xffff0000, v45
    v_rcp_f32 v45, v45
    v_sub_f32 v24, v24, v40
    v_sub_f32 v25, v25, v40
    v_sub_f32 v26, v26, v40
    v_sub_f32 v27, v27, v40
    v_sub_f32 v28, v28, v40
    v_sub_f32 v29, v29, v40
    v_sub_f32 v30, v30, v40
    v_sub_f32 v31, v31, v40
    v_cvt_pk_bf16_f32 v16, v24, v25
    v_cvt_pk_bf16_f32 v17, v26, v27
    v_cvt_pk_bf16_f32 v18, v28, v29
    v_cvt_pk_bf16_f32 v19, v30, v31
    v_lshlrev_b32 v24, 16, v16
    v_and_b32 v25, 0xffff0000, v16
    v_lshlrev_b32 v26, 16, v17
    v_and_b32 v27, 0xffff0000, v17
    v_lshlrev_b32 v28, 16, v18
    v_and_b32 v29, 0xffff0000, v18
    v_lshlrev_b32 v30, 16, v19
    v_and_b32 v31, 0xffff0000, v19
    v_mul_f32 v24, v24, v44
    v_mul_f32 v25, v25, v44
    v_mul_f32 v26, v26, v44
    v_mul_f32 v27, v27, v44
    v_mul_f32 v28, v28, v44
    v_mul_f32 v29, v29, v44
    v_mul_f32 v30, v30, v44
    v_mul_f32 v31, v31, v44
    v_cvt_pk_bf16_f32 v16, v24, v25
    v_cvt_pk_bf16_f32 v17, v26, v27
    v_cvt_pk_bf16_f32 v18, v28, v29
    v_cvt_pk_bf16_f32 v19, v30, v31
    v_sub_f32 v32, v32, v41
    v_sub_f32 v33, v33, v41
    v_sub_f32 v34, v34, v41
    v_sub_f32 v35, v35, v41
    v_sub_f32 v36, v36, v41
    v_sub_f32 v37, v37, v41
    v_sub_f32 v38, v38, v41
    v_sub_f32 v39, v39, v41
    v_cvt_pk_bf16_f32 v20, v32, v33
    v_cvt_pk_bf16_f32 v21, v34, v35
    v_cvt_pk_bf16_f32 v22, v36, v37
    v_cvt_pk_bf16_f32 v23, v38, v39
    v_lshlrev_b32 v32, 16, v20
    v_and_b32 v33, 0xffff0000, v20
    v_lshlrev_b32 v34, 16, v21
    v_and_b32 v35, 0xffff0000, v21
    v_lshlrev_b32 v36, 16, v22
    v_and_b32 v37, 0xffff0000, v22
    v_lshlrev_b32 v38, 16, v23
    v_and_b32 v39, 0xffff0000, v23
    v_mul_f32 v32, v32, v45
    v_mul_f32 v33, v33, v45
    v_mul_f32 v34, v34, v45
    v_mul_f32 v35, v35, v45
    v_mul_f32 v36, v36, v45
    v_mul_f32 v37, v37, v45
    v_mul_f32 v38, v38, v45
    v_mul_f32 v39, v39, v45
    v_cvt_pk_bf16_f32 v20, v32, v33
    v_cvt_pk_bf16_f32 v21, v34, v35
    v_cvt_pk_bf16_f32 v22, v36, v37
    v_cvt_pk_bf16_f32 v23, v38, v39
    s_mul_i32 s78, s74, 1824
    s_add_u32 s78, s78, 147456
    v_add_u32 v8, s78, v8
    s_mov_b32 exec_hi, 0x00ffffff
    ds_write_b128 v8, v[16:19]
    ds_write_b128 v8, v[20:23] offset:912
    s_mov_b64 exec, -1
    s_waitcnt vmcnt(0)
    v_mov_b32 v17, 155860
    v_mov_b32 v16, 1
    s_mov_b64 exec, 1
    s_waitcnt lgkmcnt(0)
    ds_add_u32 v17, v16
    s_mov_b64 exec, -1
    v_mov_b32 v17, 155860
    s_mov_b32 s96, 0
L_sp17:
    ds_read_b32 v16, v17
    s_waitcnt lgkmcnt(0)
    v_readfirstlane_b32 s95, v16
    s_cmp_ge_u32 s95, 4
    s_cbranch_scc1 L_sd18
    s_sleep 0
    s_add_u32 s96, s96, 1
    s_cmp_lt_u32 s96, 4194304
    s_cbranch_scc1 L_sp17
L_sd18:
L_noln:
    s_waitcnt lgkmcnt(0)
    s_mul_i32 s4, s4, 0x9e3779b1
    s_add_u32 s4, s4, 0x7f4a7c15
    s_mul_i32 s5, s5, 0x85ebca6d
    s_add_u32 s5, s5, 0x165667b1
    s_cmp_lg_u32 s3, 1
    s_cbranch_scc1 L_noq
    s_lshl_b32 s80, s74, 5
    v_add_u32 v8, s80, v63
    v_add_u32 v9, 0x10000, v8
    ds_read_b128 v[64:67], v13 offset:0
    ds_read_b64_tr_b16 v[128:129], v8 offset:16384
    ds_read_b64_tr_b16 v[130:131], v8 offset:16896
    ds_read_b128 v[68:71], v13 offset:64
    ds_read_b64_tr_b16 v[132:133], v8 offset:49152
    ds_read_b64_tr_b16 v[134:135], v8 offset:49664
    ds_read_b128 v[72:75], v13 offset:128
    ds_read_b64_tr_b16 v[136:137], v9 offset:16384
    ds_read_b64_tr_b16 v[138:139], v9 offset:16896
    ds_read_b128 v[76:79], v13 offset:192
    ds_read_b64_tr_b16 v[140:141], v9 offset:49152
    ds_read_b64_tr_b16 v[142:143], v9 offset:49664
    ds_read_b128 v[80:83], v13 offset:256
    ds_read_b64_tr_b16 v[144:145], v8 offset:20480
    ds_read_b64_tr_b16 v[146:147], v8 offset:20992
    ds_read_b128 v[84:87], v13 offset:320
    ds_read_b64_tr_b16 v[148:149], v8 offset:53248
    ds_read_b64_tr_b16 v[150:151], v8 offset:53760
    ds_read_b128 v[88:91], v13 offset:384
    ds_read_b64_tr_b16 v[152:153], v9 offset:20480
    ds_read_b64_tr_b16 v[154:155], v9 offset:20992
    ds_read_b128 v[92:95], v13 offset:448
    ds_read_b64_tr_b16 v[156:157], v9 offset:53248
    ds_read_b64_tr_b16 v[158:159], v9 offset:53760
    ds_read_b128 v[96:99], v13 offset:512
    ds_read_b64_tr_b16 v[160:161], v8 offset:24576
    ds_read_b64_tr_b16 v[162:163], v8 offset:25088
    ds_read_b128 v[100:103], v13 offset:576
    ds_read_b64_tr_b16 v[164:165], v8 offset:57344
    ds_read_b64_tr_b16 v[166:167], v8 offset:57856
    ds_read_b128 v[104:107], v13 offset:640
    ds_read_b64_tr_b16 v[168:169], v9 offset:24576
    ds_read_b64_tr_b16 v[170:171], v9 offset:25088
    ds_read_b128 v[108:111], v13 offset:704
    ds_read_b64_tr_b16 v[172:173], v9 offset:57344
    ds_read_b64_tr_b16 v[174:175], v9 offset:57856
    ds_read_b128 v[112:115], v13 offset:768
    ds_read_b64_tr_b16 v[176:177], v8 offset:28672
    ds_read_b64_tr_b16 v[178:179], v8 offset:29184
    ds_read_b128 v[116:119], v13 offset:832
    ds_read_b64_tr_b16 v[180:181], v8 offset:61440
    ds_read_b64_tr_b16 v[182:183], v8 offset:61952
    s_lshl_b32 s80, s79, 8
    s_lshl_b32 s82, s74, 6
    s_add_u32 s80, s80, s82
    s_add_u32 s80, s80, 589824
    v_lshlrev_b32 v10, 14, v6
    v_lshl_add_u32 v10, v7, 4, v10
    v_add_u32 v10, s80, v10
    v_mov_b32 v21, s4
    v_mov_b32 v23, s5
    v_mov_b32 v24, 155864
    v_mov_b32 v25, 1
    s_waitcnt lgkmcnt(15)
    v_mfma_f32_16x16x32_bf16 v[16:19], v[128:131], v[64:67], 0
    v_mfma_f32_16x16x32_bf16 v[16:19], v[132:135], v[68:71], v[16:19]
    v_mfma_f32_16x16x32_bf16 v[16:19], v[136:139], v[72:75], v[16:19]
    v_mfma_f32_16x16x32_bf16 v[16:19], v[140:143], v[76:79], v[16:19]
    v_mfma_f32_16x16x32_bf16 v[16:19], v[144:147], v[80:83], v[16:19]
    v_mfma_f32_16x16x32_bf16 v[16:19], v[148:151], v[84:87], v[16:19]
    v_mfma_f32_16x16x32_bf16 v[16:19], v[152:155], v[88:91], v[16:19]
    v_mfma_f32_16x16x32_bf16 v[16:19], v[156:159], v[92:95], v[16:19]
    v_mfma_f32_16x16x32_bf16 v[16:19], v[160:163], v[96:99], v[16:19]
    s_waitcnt lgkmcnt(12)
    v_mfma_f32_16x16x32_bf16 v[16:19], v[164:167], v[100:103], v[16:19]
    s_waitcnt lgkmcnt(9)
    v_mfma_f32_16x16x32_bf16 v[16:19], v[168:171], v[104:107], v[16:19]
    s_waitcnt lgkmcnt(6)
    v_mfma_f32_16x16x32_bf16 v[16:19], v[172:175], v[108:111], v[16:19]
    s_waitcnt lgkmcnt(3)
    v_mfma_f32_16x16x32_bf16 v[16:19], v[176:179], v[112:115], v[16:19]
    s_waitcnt lgkmcnt(0)
    v_mfma_f32_16x16x32_bf16 v[16:19], v[180:183], v[116:119], v[16:19]
    s_mov_b64 exec, 1
    ds_add_u32 v24, v25
    s_mov_b64 exec, -1
    s_nop 4
    v_cvt_pk_bf16_f32 v20, v16, v17
    v_cvt_pk_bf16_f32 v22, v18, v19
    s_mov_b32 exec_lo, 0x00ff00ff
    s_mov_b32 exec_hi, 0x00ff00ff
    buffer_store_dwordx4 v[20:23], v10, s[68:71], 0 offen sc1
    s_mov_b64 exec, -1
L_noq:
    s_cmp_lt_u32 s74, 3
    s_cbranch_scc1 L_nolead
    s_cmp_eq_u32 s3, 1
    s_cbranch_scc1 L_qd
    v_mov_b32 v17, 155884
    s_mov_b32 s96, 0
L_sp19:
    ds_read_b32 v16, v17
    s_waitcnt lgkmcnt(0)
    v_readfirstlane_b32 s95, v16
    s_cmp_ge_u32 s95, 1
    s_cbranch_scc1 L_sd20
    s_sleep 2
    s_add_u32 s96, s96, 1
    s_cmp_lt_u32 s96, 2097152
    s_cbranch_scc1 L_sp19
L_sd20:
L_qd:
    s_lshl_b32 s80, s75, 11
    s_add_u32 s80, s80, 589824
    v_lshl_add_u32 v18, v0, 4, s80
    v_lshlrev_b32 v19, 3, v0
    v_add_u32 v19, 154752, v19
    s_mov_b32 s96, 0
L_gp21:
    buffer_load_dwordx4 v[24:27], v18, s[68:71], 0 offen sc1
    buffer_load_dwordx4 v[28:31], v18, s[68:71], 0 offen offset:1024 sc1
    s_waitcnt vmcnt(0)
    v_xor_b32 v25, s4, v25
    v_xor_b32 v27, s5, v27
    v_xor_b32 v29, s4, v29
    v_xor_b32 v31, s5, v31
    v_or_b32 v16, v25, v27
    v_or3_b32 v16, v16, v29, v31
    v_cmp_ne_u32 vcc, 0, v16
    s_cbranch_vccz L_gd22
    s_sleep 8
    s_add_u32 s96, s96, 1
    s_cmp_lt_u32 s96, 131072
    s_cbranch_scc1 L_gp21
L_gd22:
    ds_write2_b32 v19, v24, v26 offset0:0 offset1:1
    ds_write2_b32 v19, v28, v30 offset0:132 offset1:133
    s_waitcnt lgkmcnt(0)
    v_mov_b32 v17, 155840
    v_mov_b32 v16, 1
    ds_write_b32 v17, v16
    v_mov_b32 v20, -1
    v_mov_b32 v21, -1
    v_mov_b32 v22, -1
    v_mov_b32 v23, -1
    buffer_store_dwordx4 v[20:23], v2, s[68:71], 0 offen sc1
    s_mov_b32 exec_lo, 0x10001
    s_mov_b32 exec_hi, 0x10001
    buffer_store_dwordx2 v[20:21], v2, s[68:71], 0 offen offset:256 sc1
    s_mov_b64 exec, -1
L_nolead:
    s_cmp_lg_u32 s3, 2
    s_cbranch_scc1 L_noffn
    s_lshr_b32 s85, s73, 4
    s_xor_b32 s85, s85, s73
    v_mov_b32 v17, 155840
    s_mov_b32 s96, 0
L_sp23:
    ds_read_b32 v16, v17
    s_waitcnt lgkmcnt(0)
    v_readfirstlane_b32 s95, v16
    s_cmp_ge_u32 s95, 1
    s_cbranch_scc1 L_sd24
    s_sleep 4
    s_add_u32 s96, s96, 1
    s_cmp_lt_u32 s96, 2097152
    s_cbranch_scc1 L_sp23
L_sd24:
    v_add_u32 v8, s81, v63
    v_lshl_add_u32 v11, v0, 4, s81
    v_mul_u32_u24 v9, 3584, v14
    v_add_u32 v9, v9, v15
    s_lshl_b32 s80, s85, 7
    v_add_u32 v9, s80, v9
    s_lshl_b32 s80, s74, 6
    v_add_u32 v13, s80, v13
    s_mul_i32 s82, s74, 114688
    ds_read_b128 v[64:67], v13 offset:0
    s_waitcnt vmcnt(4)
    s_add_u32 s83, s82, 0
    buffer_load_dwordx4 v[128:131], v9, s[48:51], s83 offen nt
    s_add_u32 s83, s82, 28672
    buffer_load_dwordx4 v[132:135], v9, s[48:51], s83 offen nt
    s_add_u32 s83, s82, 57344
    buffer_load_dwordx4 v[136:139], v9, s[48:51], s83 offen nt
    s_add_u32 s83, s82, 86016
    buffer_load_dwordx4 v[140:143], v9, s[48:51], s83 offen nt
    s_waitcnt vmcnt(4)
    s_add_u32 s83, s82, 0
    buffer_load_dwordx4 v[144:147], v9, s[52:55], s83 offen nt
    s_add_u32 s83, s82, 28672
    buffer_load_dwordx4 v[148:151], v9, s[52:55], s83 offen nt
    s_add_u32 s83, s82, 57344
    buffer_load_dwordx4 v[152:155], v9, s[52:55], s83 offen nt
    s_add_u32 s83, s82, 86016
    buffer_load_dwordx4 v[156:159], v9, s[52:55], s83 offen nt
    ds_read_b128 v[68:71], v13 offset:256
    s_waitcnt vmcnt(4)
    s_add_u32 s83, s82, 458752
    buffer_load_dwordx4 v[160:163], v9, s[48:51], s83 offen nt
    s_add_u32 s83, s82, 487424
    buffer_load_dwordx4 v[164:167], v9, s[48:51], s83 offen nt
    s_add_u32 s83, s82, 516096
    buffer_load_dwordx4 v[168:171], v9, s[48:51], s83 offen nt
    s_add_u32 s83, s82, 544768
    buffer_load_dwordx4 v[172:175], v9, s[48:51], s83 offen nt
    s_waitcnt vmcnt(4)
    s_add_u32 s83, s82, 458752
    buffer_load_dwordx4 v[176:179], v9, s[52:55], s83 offen nt
    s_add_u32 s83, s82, 487424
    buffer_load_dwordx4 v[180:183], v9, s[52:55], s83 offen nt
    s_add_u32 s83, s82, 516096
    buffer_load_dwordx4 v[184:187], v9, s[52:55], s83 offen nt
    s_add_u32 s83, s82, 544768
    buffer_load_dwordx4 v[188:191], v9, s[52:55], s83 offen nt
    ds_read_b128 v[72:75], v13 offset:512
    s_waitcnt vmcnt(4)
    s_add_u32 s83, s82, 917504
    buffer_load_dwordx4 v[192:195], v9, s[48:51], s83 offen nt
    s_add_u32 s83, s82, 946176
    buffer_load_dwordx4 v[196:199], v9, s[48:51], s83 offen nt
    s_add_u32 s83, s82, 974848
    buffer_load_dwordx4 v[200:203], v9, s[48:51], s83 offen nt
    s_add_u32 s83, s82, 1003520
    buffer_load_dwordx4 v[204:207], v9, s[48:51], s83 offen nt
    s_waitcnt vmcnt(4)
    s_add_u32 s83, s82, 917504
    buffer_load_dwordx4 v[208:211], v9, s[52:55], s83 offen nt
    s_add_u32 s83, s82, 946176
    buffer_load_dwordx4 v[212:215], v9, s[52:55], s83 offen nt
    s_add_u32 s83, s82, 974848
    buffer_load_dwordx4 v[216:219], v9, s[52:55], s83 offen nt
    s_add_u32 s83, s82, 1003520
    buffer_load_dwordx4 v[220:223], v9, s[52:55], s83 offen nt
    ds_read_b128 v[76:79], v13 offset:768
    s_waitcnt vmcnt(4)
    s_add_u32 s83, s82, 1376256
    buffer_load_dwordx4 v[224:227], v9, s[48:51], s83 offen nt
    s_add_u32 s83, s82, 1404928
    buffer_load_dwordx4 v[228:231], v9, s[48:51], s83 offen nt
    s_add_u32 s83, s82, 1433600
    buffer_load_dwordx4 v[232:235], v9, s[48:51], s83 offen nt
    s_add_u32 s83, s82, 1462272
    buffer_load_dwordx4 v[236:239], v9, s[48:51], s83 offen nt
    s_waitcnt vmcnt(4)
    s_add_u32 s83, s82, 1376256
    buffer_load_dwordx4 v[240:243], v9, s[52:55], s83 offen nt
    s_add_u32 s83, s82, 1404928
    buffer_load_dwordx4 v[244:247], v9, s[52:55], s83 offen nt
    s_add_u32 s83, s82, 1433600
    buffer_load_dwordx4 v[248:251], v9, s[52:55], s83 offen nt
    s_add_u32 s83, s82, 1462272
    buffer_load_dwordx4 v[252:255], v9, s[52:55], s83 offen nt
    s_waitcnt vmcnt(0)
    ds_write_b128 v11, v[128:131] offset:0
    ds_write_b128 v11, v[132:135] offset:1024
    ds_write_b128 v11, v[136:139] offset:2048
    ds_write_b128 v11, v[140:143] offset:3072
    ds_read_b64_tr_b16 v[24:25], v8 offset:0
    ds_read_b64_tr_b16 v[26:27], v8 offset:512
    ds_read_b64_tr_b16 v[28:29], v8 offset:32
    ds_read_b64_tr_b16 v[30:31], v8 offset:544
    ds_read_b64_tr_b16 v[32:33], v8 offset:64
    ds_read_b64_tr_b16 v[34:35], v8 offset:576
    ds_read_b64_tr_b16 v[36:37], v8 offset:96
    ds_read_b64_tr_b16 v[38:39], v8 offset:608
    s_waitcnt lgkmcnt(0)
    v_mfma_f32_16x16x32_bf16 v[96:99], v[24:27], v[64:67], 0
    v_mfma_f32_16x16x32_bf16 v[100:103], v[28:31], v[64:67], 0
    v_mfma_f32_16x16x32_bf16 v[104:107], v[32:35], v[64:67], 0
    v_mfma_f32_16x16x32_bf16 v[108:111], v[36:39], v[64:67], 0
    ds_write_b128 v11, v[144:147] offset:0
    ds_write_b128 v11, v[148:151] offset:1024
    ds_write_b128 v11, v[152:155] offset:2048
    ds_write_b128 v11, v[156:159] offset:3072
    ds_read_b64_tr_b16 v[24:25], v8 offset:0
    ds_read_b64_tr_b16 v[26:27], v8 offset:512
    ds_read_b64_tr_b16 v[28:29], v8 offset:32
    ds_read_b64_tr_b16 v[30:31], v8 offset:544
    ds_read_b64_tr_b16 v[32:33], v8 offset:64
    ds_read_b64_tr_b16 v[34:35], v8 offset:576
    ds_read_b64_tr_b16 v[36:37], v8 offset:96
    ds_read_b64_tr_b16 v[38:39], v8 offset:608
    s_waitcnt lgkmcnt(0)
    v_mfma_f32_16x16x32_bf16 v[112:115], v[24:27], v[64:67], 0
    v_mfma_f32_16x16x32_bf16 v[116:119], v[28:31], v[64:67], 0
    v_mfma_f32_16x16x32_bf16 v[120:123], v[32:35], v[64:67], 0
    v_mfma_f32_16x16x32_bf16 v[124:127], v[36:39], v[64:67], 0
    ds_write_b128 v11, v[160:163] offset:0
    ds_write_b128 v11, v[164:167] offset:1024
    ds_write_b128 v11, v[168:171] offset:2048
    ds_write_b128 v11, v[172:175] offset:3072
    ds_read_b64_tr_b16 v[24:25], v8 offset:0
    ds_read_b64_tr_b16 v[26:27], v8 offset:512
    ds_read_b64_tr_b16 v[28:29], v8 offset:32
    ds_read_b64_tr_b16 v[30:31], v8 offset:544
    ds_read_b64_tr_b16 v[32:33], v8 offset:64
    ds_read_b64_tr_b16 v[34:35], v8 offset:576
    ds_read_b64_tr_b16 v[36:37], v8 offset:96
    ds_read_b64_tr_b16 v[38:39], v8 offset:608
    s_waitcnt lgkmcnt(0)
    v_mfma_f32_16x16x32_bf16 v[96:99], v[24:27], v[68:71], v[96:99]
    v_mfma_f32_16x16x32_bf16 v[100:103], v[28:31], v[68:71], v[100:103]
    v_mfma_f32_16x16x32_bf16 v[104:107], v[32:35], v[68:71], v[104:107]
    v_mfma_f32_16x16x32_bf16 v[108:111], v[36:39], v[68:71], v[108:111]
    ds_write_b128 v11, v[176:179] offset:0
    ds_write_b128 v11, v[180:183] offset:1024
    ds_write_b128 v11, v[184:187] offset:2048
    ds_write_b128 v11, v[188:191] offset:3072
    ds_read_b64_tr_b16 v[24:25], v8 offset:0
    ds_read_b64_tr_b16 v[26:27], v8 offset:512
    ds_read_b64_tr_b16 v[28:29], v8 offset:32
    ds_read_b64_tr_b16 v[30:31], v8 offset:544
    ds_read_b64_tr_b16 v[32:33], v8 offset:64
    ds_read_b64_tr_b16 v[34:35], v8 offset:576
    ds_read_b64_tr_b16 v[36:37], v8 offset:96
    ds_read_b64_tr_b16 v[38:39], v8 offset:608
    s_waitcnt lgkmcnt(0)
    v_mfma_f32_16x16x32_bf16 v[112:115], v[24:27], v[68:71], v[112:115]
    v_mfma_f32_16x16x32_bf16 v[116:119], v[28:31], v[68:71], v[116:119]
    v_mfma_f32_16x16x32_bf16 v[120:123], v[32:35], v[68:71], v[120:123]
    v_mfma_f32_16x16x32_bf16 v[124:127], v[36:39], v[68:71], v[124:127]
    ds_write_b128 v11, v[192:195] offset:0
    ds_write_b128 v11, v[196:199] offset:1024
    ds_write_b128 v11, v[200:203] offset:2048
    ds_write_b128 v11, v[204:207] offset:3072
    ds_read_b64_tr_b16 v[24:25], v8 offset:0
    ds_read_b64_tr_b16 v[26:27], v8 offset:512
    ds_read_b64_tr_b16 v[28:29], v8 offset:32
    ds_read_b64_tr_b16 v[30:31], v8 offset:544
    ds_read_b64_tr_b16 v[32:33], v8 offset:64
    ds_read_b64_tr_b16 v[34:35], v8 offset:576
    ds_read_b64_tr_b16 v[36:37], v8 offset:96
    ds_read_b64_tr_b16 v[38:39], v8 offset:608
    s_waitcnt lgkmcnt(0)
    v_mfma_f32_16x16x32_bf16 v[96:99], v[24:27], v[72:75], v[96:99]
    v_mfma_f32_16x16x32_bf16 v[100:103], v[28:31], v[72:75], v[100:103]
    v_mfma_f32_16x16x32_bf16 v[104:107], v[32:35], v[72:75], v[104:107]
    v_mfma_f32_16x16x32_bf16 v[108:111], v[36:39], v[72:75], v[108:111]
    ds_write_b128 v11, v[208:211] offset:0
    ds_write_b128 v11, v[212:215] offset:1024
    ds_write_b128 v11, v[216:219] offset:2048
    ds_write_b128 v11, v[220:223] offset:3072
    ds_read_b64_tr_b16 v[24:25], v8 offset:0
    ds_read_b64_tr_b16 v[26:27], v8 offset:512
    ds_read_b64_tr_b16 v[28:29], v8 offset:32
    ds_read_b64_tr_b16 v[30:31], v8 offset:544
    ds_read_b64_tr_b16 v[32:33], v8 offset:64
    ds_read_b64_tr_b16 v[34:35], v8 offset:576
    ds_read_b64_tr_b16 v[36:37], v8 offset:96
    ds_read_b64_tr_b16 v[38:39], v8 offset:608
    s_waitcnt lgkmcnt(0)
    v_mfma_f32_16x16x32_bf16 v[112:115], v[24:27], v[72:75], v[112:115]
    v_mfma_f32_16x16x32_bf16 v[116:119], v[28:31], v[72:75], v[116:119]
    v_mfma_f32_16x16x32_bf16 v[120:123], v[32:35], v[72:75], v[120:123]
    v_mfma_f32_16x16x32_bf16 v[124:127], v[36:39], v[72:75], v[124:127]
    s_cmp_ge_u32 s74, 2
    s_cbranch_scc1 L_fa
    ds_write_b128 v11, v[224:227] offset:0
    ds_write_b128 v11, v[228:231] offset:1024
    ds_write_b128 v11, v[232:235] offset:2048
    ds_write_b128 v11, v[236:239] offset:3072
    ds_read_b64_tr_b16 v[24:25], v8 offset:0
    ds_read_b64_tr_b16 v[26:27], v8 offset:512
    ds_read_b64_tr_b16 v[28:29], v8 offset:32
    ds_read_b64_tr_b16 v[30:31], v8 offset:544
    ds_read_b64_tr_b16 v[32:33], v8 offset:64
    ds_read_b64_tr_b16 v[34:35], v8 offset:576
    ds_read_b64_tr_b16 v[36:37], v8 offset:96
    ds_read_b64_tr_b16 v[38:39], v8 offset:608
    s_waitcnt lgkmcnt(0)
    v_mfma_f32_16x16x32_bf16 v[96:99], v[24:27], v[76:79], v[96:99]
    v_mfma_f32_16x16x32_bf16 v[100:103], v[28:31], v[76:79], v[100:103]
    v_mfma_f32_16x16x32_bf16 v[104:107], v[32:35], v[76:79], v[104:107]
    v_mfma_f32_16x16x32_bf16 v[108:111], v[36:39], v[76:79], v[108:111]
    ds_write_b128 v11, v[240:243] offset:0
    ds_write_b128 v11, v[244:247] offset:1024
    ds_write_b128 v11, v[248:251] offset:2048
    ds_write_b128 v11, v[252:255] offset:3072
    ds_read_b64_tr_b16 v[24:25], v8 offset:0
    ds_read_b64_tr_b16 v[26:27], v8 offset:512
    ds_read_b64_tr_b16 v[28:29], v8 offset:32
    ds_read_b64_tr_b16 v[30:31], v8 offset:544
    ds_read_b64_tr_b16 v[32:33], v8 offset:64
    ds_read_b64_tr_b16 v[34:35], v8 offset:576
    ds_read_b64_tr_b16 v[36:37], v8 offset:96
    ds_read_b64_tr_b16 v[38:39], v8 offset:608
    s_waitcnt lgkmcnt(0)
    v_mfma_f32_16x16x32_bf16 v[112:115], v[24:27], v[76:79], v[112:115]
    v_mfma_f32_16x16x32_bf16 v[116:119], v[28:31], v[76:79], v[116:119]
    v_mfma_f32_16x16x32_bf16 v[120:123], v[32:35], v[76:79], v[120:123]
    v_mfma_f32_16x16x32_bf16 v[124:127], v[36:39], v[76:79], v[124:127]
L_fa:
    v_mul_u32_u24 v9, 896, v14
    v_add_u32 v9, v9, v15
    s_lshl_b32 s80, s74, 7
    v_add_u32 v9, s80, v9
    s_mul_i32 s82, s85, 57344
    s_waitcnt vmcnt(4)
    s_add_u32 s83, s82, 0
    buffer_load_dwordx4 v[192:195], v9, s[56:59], s83 offen nt
    s_add_u32 s83, s82, 7168
    buffer_load_dwordx4 v[196:199], v9, s[56:59], s83 offen nt
    s_add_u32 s83, s82, 14336
    buffer_load_dwordx4 v[200:203], v9, s[56:59], s83 offen nt
    s_add_u32 s83, s82, 21504
    buffer_load_dwordx4 v[204:207], v9, s[56:59], s83 offen nt
    s_waitcnt vmcnt(4)
    s_add_u32 s83, s82, 28672
    buffer_load_dwordx4 v[208:211], v9, s[56:59], s83 offen nt
    s_add_u32 s83, s82, 35840
    buffer_load_dwordx4 v[212:215], v9, s[56:59], s83 offen nt
    s_add_u32 s83, s82, 43008
    buffer_load_dwordx4 v[216:219], v9, s[56:59], s83 offen nt
    s_add_u32 s83, s82, 50176
    buffer_load_dwordx4 v[220:223], v9, s[56:59], s83 offen nt
    s_cmp_eq_u32 s74, 3
    s_cbranch_scc1 L_fa2
    s_waitcnt vmcnt(4)
    s_add_u32 s83, s82, 512
    buffer_load_dwordx4 v[224:227], v9, s[56:59], s83 offen nt
    s_add_u32 s83, s82, 7680
    buffer_load_dwordx4 v[228:231], v9, s[56:59], s83 offen nt
    s_add_u32 s83, s82, 14848
    buffer_load_dwordx4 v[232:235], v9, s[56:59], s83 offen nt
    s_add_u32 s83, s82, 22016
    buffer_load_dwordx4 v[236:239], v9, s[56:59], s83 offen nt
    s_waitcnt vmcnt(4)
    s_add_u32 s83, s82, 29184
    buffer_load_dwordx4 v[240:243], v9, s[56:59], s83 offen nt
    s_add_u32 s83, s82, 36352
    buffer_load_dwordx4 v[244:247], v9, s[56:59], s83 offen nt
    s_add_u32 s83, s82, 43520
    buffer_load_dwordx4 v[248:251], v9, s[56:59], s83 offen nt
    s_add_u32 s83, s82, 50688
    buffer_load_dwordx4 v[252:255], v9, s[56:59], s83 offen nt
L_fa2:
    v_lshlrev_b32 v16, 8, v6
    v_lshl_add_u32 v16, v7, 4, v16
    v_add_u32 v16, s81, v16
    s_mov_b32 exec_lo, 0x00ff00ff
    s_mov_b32 exec_hi, 0x00ff00ff
    ds_write_b128 v16, v[96:99] offset:0
    ds_write_b128 v16, v[100:103] offset:64
    ds_write_b128 v16, v[104:107] offset:128
    ds_write_b128 v16, v[108:111] offset:192
    ds_write_b128 v16, v[112:115] offset:2048
    ds_write_b128 v16, v[116:119] offset:2112
    ds_write_b128 v16, v[120:123] offset:2176
    ds_write_b128 v16, v[124:127] offset:2240
    s_mov_b64 exec, -1
    v_mov_b32 v17, 155868
    v_mov_b32 v16, 1
    s_mov_b64 exec, 1
    s_waitcnt lgkmcnt(0)
    ds_add_u32 v17, v16
    s_mov_b64 exec, -1
    v_mov_b32 v17, 155868
    s_mov_b32 s96, 0
L_sp25:
    ds_read_b32 v16, v17
    s_waitcnt lgkmcnt(0)
    v_readfirstlane_b32 s95, v16
    s_cmp_ge_u32 s95, 4
    s_cbranch_scc1 L_sd26
    s_sleep 0
    s_add_u32 s96, s96, 1
    s_cmp_lt_u32 s96, 4194304
    s_cbranch_scc1 L_sp25
L_sd26:
    v_and_b32 v16, 7, v0
    v_lshlrev_b32 v16, 8, v16
    v_lshl_add_u32 v16, v7, 5, v16
    v_add_u32 v16, 131072, v16
    ds_read_b128 v[128:131], v16 offset:0
    ds_read_b128 v[132:135], v16 offset:16
    ds_read_b128 v[136:139], v16 offset:4096
    ds_read_b128 v[140:143], v16 offset:4112
    ds_read_b128 v[144:147], v16 offset:8192
    ds_read_b128 v[148:151], v16 offset:8208
    ds_read_b128 v[152:155], v16 offset:12288
    ds_read_b128 v[156:159], v16 offset:12304
    ds_read_b128 v[160:163], v16 offset:2048
    ds_read_b128 v[164:167], v16 offset:2064
    ds_read_b128 v[168:171], v16 offset:6144
    ds_read_b128 v[172:175], v16 offset:6160
    ds_read_b128 v[176:179], v16 offset:10240
    ds_read_b128 v[180:183], v16 offset:10256
    ds_read_b128 v[184:187], v16 offset:14336
    ds_read_b128 v[188:191], v16 offset:14352
    s_waitcnt lgkmcnt(0)
    v_add_f32 v128, v128, v136
    v_add_f32 v144, v144, v152
    v_add_f32 v128, v128, v144
    v_cvt_pk_bf16_f32 v128, v128, v128
    v_and_b32 v128, 0xffff0000, v128
    v_add_f32 v129, v129, v137
    v_add_f32 v145, v145, v153
    v_add_f32 v129, v129, v145
    v_cvt_pk_bf16_f32 v129, v129, v129
    v_and_b32 v129, 0xffff0000, v129
    v_add_f32 v130, v130, v138
    v_add_f32 v146, v146, v154
    v_add_f32 v130, v130, v146
    v_cvt_pk_bf16_f32 v130, v130, v130
    v_and_b32 v130, 0xffff0000, v130
    v_add_f32 v131, v131, v139
    v_add_f32 v147, v147, v155
    v_add_f32 v131, v131, v147
    v_cvt_pk_bf16_f32 v131, v131, v131
    v_and_b32 v131, 0xffff0000, v131
    v_add_f32 v132, v132, v140
    v_add_f32 v148, v148, v156
    v_add_f32 v132, v132, v148
    v_cvt_pk_bf16_f32 v132, v132, v132
    v_and_b32 v132, 0xffff0000, v132
    v_add_f32 v133, v133, v141
    v_add_f32 v149, v149, v157
    v_add_f32 v133, v133, v149
    v_cvt_pk_bf16_f32 v133, v133, v133
    v_and_b32 v133, 0xffff0000, v133
    v_add_f32 v134, v134, v142
    v_add_f32 v150, v150, v158
    v_add_f32 v134, v134, v150
    v_cvt_pk_bf16_f32 v134, v134, v134
    v_and_b32 v134, 0xffff0000, v134
    v_add_f32 v135, v135, v143
    v_add_f32 v151, v151, v159
    v_add_f32 v135, v135, v151
    v_cvt_pk_bf16_f32 v135, v135, v135
    v_and_b32 v135, 0xffff0000, v135
    v_add_f32 v160, v160, v168
    v_add_f32 v176, v176, v184
    v_add_f32 v160, v160, v176
    v_cvt_pk_bf16_f32 v160, v160, v160
    v_and_b32 v160, 0xffff0000, v160
    v_add_f32 v161, v161, v169
    v_add_f32 v177, v177, v185
    v_add_f32 v161, v161, v177
    v_cvt_pk_bf16_f32 v161, v161, v161
    v_and_b32 v161, 0xffff0000, v161
    v_add_f32 v162, v162, v170
    v_add_f32 v178, v178, v186
    v_add_f32 v162, v162, v178
    v_cvt_pk_bf16_f32 v162, v162, v162
    v_and_b32 v162, 0xffff0000, v162
    v_add_f32 v163, v163, v171
    v_add_f32 v179, v179, v187
    v_add_f32 v163, v163, v179
    v_cvt_pk_bf16_f32 v163, v163, v163
    v_and_b32 v163, 0xffff0000, v163
    v_add_f32 v164, v164, v172
    v_add_f32 v180, v180, v188
    v_add_f32 v164, v164, v180
    v_cvt_pk_bf16_f32 v164, v164, v164
    v_and_b32 v164, 0xffff0000, v164
    v_add_f32 v165, v165, v173
    v_add_f32 v181, v181, v189
    v_add_f32 v165, v165, v181
    v_cvt_pk_bf16_f32 v165, v165, v165
    v_and_b32 v165, 0xffff0000, v165
    v_add_f32 v166, v166, v174
    v_add_f32 v182, v182, v190
    v_add_f32 v166, v166, v182
    v_cvt_pk_bf16_f32 v166, v166, v166
    v_and_b32 v166, 0xffff0000, v166
    v_add_f32 v167, v167, v175
    v_add_f32 v183, v183, v191
    v_add_f32 v167, v167, v183
    v_cvt_pk_bf16_f32 v167, v167, v167
    v_and_b32 v167, 0xffff0000, v167
    v_mul_f32 v128, v128, v160
    v_mul_f32 v129, v129, v161
    v_mul_f32 v130, v130, v162
    v_mul_f32 v131, v131, v163
    v_mul_f32 v132, v132, v164
    v_mul_f32 v133, v133, v165
    v_mul_f32 v134, v134, v166
    v_mul_f32 v135, v135, v167
    v_cvt_pk_bf16_f32 v48, v128, v129
    v_cvt_pk_bf16_f32 v49, v130, v131
    v_cvt_pk_bf16_f32 v50, v132, v133
    v_cvt_pk_bf16_f32 v51, v134, v135
    ds_read_b128 v[128:131], v16 offset:128
    ds_read_b128 v[132:135], v16 offset:144
    ds_read_b128 v[136:139], v16 offset:4224
    ds_read_b128 v[140:143], v16 offset:4240
    ds_read_b128 v[144:147], v16 offset:8320
    ds_read_b128 v[148:151], v16 offset:8336
    ds_read_b128 v[152:155], v16 offset:12416
    ds_read_b128 v[156:159], v16 offset:12432
    ds_read_b128 v[160:163], v16 offset:2176
    ds_read_b128 v[164:167], v16 offset:2192
    ds_read_b128 v[168:171], v16 offset:6272
    ds_read_b128 v[172:175], v16 offset:6288
    ds_read_b128 v[176:179], v16 offset:10368
    ds_read_b128 v[180:183], v16 offset:10384
    ds_read_b128 v[184:187], v16 offset:14464
    ds_read_b128 v[188:191], v16 offset:14480
    s_waitcnt lgkmcnt(0)
    v_add_f32 v128, v128, v136
    v_add_f32 v144, v144, v152
    v_add_f32 v128, v128, v144
    v_cvt_pk_bf16_f32 v128, v128, v128
    v_and_b32 v128, 0xffff0000, v128
    v_add_f32 v129, v129, v137
    v_add_f32 v145, v145, v153
    v_add_f32 v129, v129, v145
    v_cvt_pk_bf16_f32 v129, v129, v129
    v_and_b32 v129, 0xffff0000, v129
    v_add_f32 v130, v130, v138
    v_add_f32 v146, v146, v154
    v_add_f32 v130, v130, v146
    v_cvt_pk_bf16_f32 v130, v130, v130
    v_and_b32 v130, 0xffff0000, v130
    v_add_f32 v131, v131, v139
    v_add_f32 v147, v147, v155
    v_add_f32 v131, v131, v147
    v_cvt_pk_bf16_f32 v131, v131, v131
    v_and_b32 v131, 0xffff0000, v131
    v_add_f32 v132, v132, v140
    v_add_f32 v148, v148, v156
    v_add_f32 v132, v132, v148
    v_cvt_pk_bf16_f32 v132, v132, v132
    v_and_b32 v132, 0xffff0000, v132
    v_add_f32 v133, v133, v141
    v_add_f32 v149, v149, v157
    v_add_f32 v133, v133, v149
    v_cvt_pk_bf16_f32 v133, v133, v133
    v_and_b32 v133, 0xffff0000, v133
    v_add_f32 v134, v134, v142
    v_add_f32 v150, v150, v158
    v_add_f32 v134, v134, v150
    v_cvt_pk_bf16_f32 v134, v134, v134
    v_and_b32 v134, 0xffff0000, v134
    v_add_f32 v135, v135, v143
    v_add_f32 v151, v151, v159
    v_add_f32 v135, v135, v151
    v_cvt_pk_bf16_f32 v135, v135, v135
    v_and_b32 v135, 0xffff0000, v135
    v_add_f32 v160, v160, v168
    v_add_f32 v176, v176, v184
    v_add_f32 v160, v160, v176
    v_cvt_pk_bf16_f32 v160, v160, v160
    v_and_b32 v160, 0xffff0000, v160
    v_add_f32 v161, v161, v169
    v_add_f32 v177, v177, v185
    v_add_f32 v161, v161, v177
    v_cvt_pk_bf16_f32 v161, v161, v161
    v_and_b32 v161, 0xffff0000, v161
    v_add_f32 v162, v162, v170
    v_add_f32 v178, v178, v186
    v_add_f32 v162, v162, v178
    v_cvt_pk_bf16_f32 v162, v162, v162
    v_and_b32 v162, 0xffff0000, v162
    v_add_f32 v163, v163, v171
    v_add_f32 v179, v179, v187
    v_add_f32 v163, v163, v179
    v_cvt_pk_bf16_f32 v163, v163, v163
    v_and_b32 v163, 0xffff0000, v163
    v_add_f32 v164, v164, v172
    v_add_f32 v180, v180, v188
    v_add_f32 v164, v164, v180
    v_cvt_pk_bf16_f32 v164, v164, v164
    v_and_b32 v164, 0xffff0000, v164
    v_add_f32 v165, v165, v173
    v_add_f32 v181, v181, v189
    v_add_f32 v165, v165, v181
    v_cvt_pk_bf16_f32 v165, v165, v165
    v_and_b32 v165, 0xffff0000, v165
    v_add_f32 v166, v166, v174
    v_add_f32 v182, v182, v190
    v_add_f32 v166, v166, v182
    v_cvt_pk_bf16_f32 v166, v166, v166
    v_and_b32 v166, 0xffff0000, v166
    v_add_f32 v167, v167, v175
    v_add_f32 v183, v183, v191
    v_add_f32 v167, v167, v183
    v_cvt_pk_bf16_f32 v167, v167, v167
    v_and_b32 v167, 0xffff0000, v167
    v_mul_f32 v128, v128, v160
    v_mul_f32 v129, v129, v161
    v_mul_f32 v130, v130, v162
    v_mul_f32 v131, v131, v163
    v_mul_f32 v132, v132, v164
    v_mul_f32 v133, v133, v165
    v_mul_f32 v134, v134, v166
    v_mul_f32 v135, v135, v167
    v_cvt_pk_bf16_f32 v52, v128, v129
    v_cvt_pk_bf16_f32 v53, v130, v131
    v_cvt_pk_bf16_f32 v54, v132, v133
    v_cvt_pk_bf16_f32 v55, v134, v135
    v_mov_b32 v17, 155872
    v_mov_b32 v16, 1
    s_mov_b64 exec, 1
    s_waitcnt lgkmcnt(0)
    ds_add_u32 v17, v16
    s_mov_b64 exec, -1
    v_mov_b32 v17, 155872
    s_mov_b32 s96, 0
L_sp27:
    ds_read_b32 v16, v17
    s_waitcnt lgkmcnt(0)
    v_readfirstlane_b32 s95, v16
    s_cmp_ge_u32 s95, 4
    s_cbranch_scc1 L_sd28
    s_sleep 0
    s_add_u32 s96, s96, 1
    s_cmp_lt_u32 s96, 4194304
    s_cbranch_scc1 L_sp27
L_sd28:
    s_mul_i32 s80, s85, 14336
    s_lshl_b32 s82, s74, 8
    s_add_u32 s80, s80, s82
    s_add_u32 s80, s80, 1048576
    v_mul_u32_u24 v10, 1792, v6
    v_lshl_add_u32 v10, v7, 4, v10
    v_add_u32 v10, s80, v10
    s_waitcnt vmcnt(0)
    ds_write_b128 v11, v[192:195] offset:0
    ds_write_b128 v11, v[196:199] offset:1024
    ds_write_b128 v11, v[200:203] offset:2048
    ds_write_b128 v11, v[204:207] offset:3072
    ds_read_b64_tr_b16 v[24:25], v8 offset:0
    ds_read_b64_tr_b16 v[26:27], v8 offset:512
    ds_read_b64_tr_b16 v[28:29], v8 offset:32
    ds_read_b64_tr_b16 v[30:31], v8 offset:544
    ds_read_b64_tr_b16 v[32:33], v8 offset:64
    ds_read_b64_tr_b16 v[34:35], v8 offset:576
    ds_read_b64_tr_b16 v[36:37], v8 offset:96
    ds_read_b64_tr_b16 v[38:39], v8 offset:608
    s_waitcnt lgkmcnt(0)
    v_mfma_f32_16x16x32_bf16 v[96:99], v[24:27], v[48:51], 0
    v_mfma_f32_16x16x32_bf16 v[100:103], v[28:31], v[48:51], 0
    v_mfma_f32_16x16x32_bf16 v[104:107], v[32:35], v[48:51], 0
    v_mfma_f32_16x16x32_bf16 v[108:111], v[36:39], v[48:51], 0
    ds_write_b128 v11, v[208:211] offset:0
    ds_write_b128 v11, v[212:215] offset:1024
    ds_write_b128 v11, v[216:219] offset:2048
    ds_write_b128 v11, v[220:223] offset:3072
    ds_read_b64_tr_b16 v[24:25], v8 offset:0
    ds_read_b64_tr_b16 v[26:27], v8 offset:512
    ds_read_b64_tr_b16 v[28:29], v8 offset:32
    ds_read_b64_tr_b16 v[30:31], v8 offset:544
    ds_read_b64_tr_b16 v[32:33], v8 offset:64
    ds_read_b64_tr_b16 v[34:35], v8 offset:576
    ds_read_b64_tr_b16 v[36:37], v8 offset:96
    ds_read_b64_tr_b16 v[38:39], v8 offset:608
    s_waitcnt lgkmcnt(0)
    v_mfma_f32_16x16x32_bf16 v[96:99], v[24:27], v[52:55], v[96:99]
    v_mfma_f32_16x16x32_bf16 v[100:103], v[28:31], v[52:55], v[100:103]
    v_mfma_f32_16x16x32_bf16 v[104:107], v[32:35], v[52:55], v[104:107]
    v_mfma_f32_16x16x32_bf16 v[108:111], v[36:39], v[52:55], v[108:111]
    s_nop 7
    s_mov_b32 exec_lo, 0x00ff00ff
    s_mov_b32 exec_hi, 0x00ff00ff
    buffer_store_dwordx4 v[96:99], v10, s[68:71], 0 offen offset:0 sc1
    buffer_store_dwordx4 v[100:103], v10, s[68:71], 0 offen offset:64 sc1
    buffer_store_dwordx4 v[104:107], v10, s[68:71], 0 offen offset:128 sc1
    buffer_store_dwordx4 v[108:111], v10, s[68:71], 0 offen offset:192 sc1
    s_mov_b64 exec, -1
    s_cmp_eq_u32 s74, 3
    s_cbranch_scc1 L_fb
    ds_write_b128 v11, v[224:227] offset:0
    ds_write_b128 v11, v[228:231] offset:1024
    ds_write_b128 v11, v[232:235] offset:2048
    ds_write_b128 v11, v[236:239] offset:3072
    ds_read_b64_tr_b16 v[24:25], v8 offset:0
    ds_read_b64_tr_b16 v[26:27], v8 offset:512
    ds_read_b64_tr_b16 v[28:29], v8 offset:32
    ds_read_b64_tr_b16 v[30:31], v8 offset:544
    ds_read_b64_tr_b16 v[32:33], v8 offset:64
    ds_read_b64_tr_b16 v[34:35], v8 offset:576
    ds_read_b64_tr_b16 v[36:37], v8 offset:96
    ds_read_b64_tr_b16 v[38:39], v8 offset:608
    s_waitcnt lgkmcnt(0)
    v_mfma_f32_16x16x32_bf16 v[112:115], v[24:27], v[48:51], 0
    v_mfma_f32_16x16x32_bf16 v[116:119], v[28:31], v[48:51], 0
    v_mfma_f32_16x16x32_bf16 v[120:123], v[32:35], v[48:51], 0
    v_mfma_f32_16x16x32_bf16 v[124:127], v[36:39], v[48:51], 0
    ds_write_b128 v11, v[240:243] offset:0
    ds_write_b128 v11, v[244:247] offset:1024
    ds_write_b128 v11, v[248:251] offset:2048
    ds_write_b128 v11, v[252:255] offset:3072
    ds_read_b64_tr_b16 v[24:25], v8 offset:0
    ds_read_b64_tr_b16 v[26:27], v8 offset:512
    ds_read_b64_tr_b16 v[28:29], v8 offset:32
    ds_read_b64_tr_b16 v[30:31], v8 offset:544
    ds_read_b64_tr_b16 v[32:33], v8 offset:64
    ds_read_b64_tr_b16 v[34:35], v8 offset:576
    ds_read_b64_tr_b16 v[36:37], v8 offset:96
    ds_read_b64_tr_b16 v[38:39], v8 offset:608
    s_waitcnt lgkmcnt(0)
    v_mfma_f32_16x16x32_bf16 v[112:115], v[24:27], v[52:55], v[112:115]
    v_mfma_f32_16x16x32_bf16 v[116:119], v[28:31], v[52:55], v[116:119]
    v_mfma_f32_16x16x32_bf16 v[120:123], v[32:35], v[52:55], v[120:123]
    v_mfma_f32_16x16x32_bf16 v[124:127], v[36:39], v[52:55], v[124:127]
    s_nop 7
    s_mov_b32 exec_lo, 0x00ff00ff
    s_mov_b32 exec_hi, 0x00ff00ff
    buffer_store_dwordx4 v[112:115], v10, s[68:71], 0 offen offset:1024 sc1
    buffer_store_dwordx4 v[116:119], v10, s[68:71], 0 offen offset:1088 sc1
    buffer_store_dwordx4 v[120:123], v10, s[68:71], 0 offen offset:1152 sc1
    buffer_store_dwordx4 v[124:127], v10, s[68:71], 0 offen offset:1216 sc1
    s_mov_b64 exec, -1
L_fb:
L_noffn:
    s_and_b32 s78, s73, 3
    s_lshl_b32 s78, s78, 3
    s_add_u32 s78, s78, s72
    s_lshr_b32 s72, s73, 2
    s_mov_b32 s73, s78
    s_lshr_b32 s78, s74, 1
    s_and_b32 s79, s74, 1
    v_mov_b32 v56, 0
    v_mov_b32 v104, 0
    v_mov_b32 v105, 0
    s_cmp_eq_u32 s72, 7
    s_cbranch_scc1 L_nowo
    v_mov_b32 v17, 155840
    s_mov_b32 s96, 0
L_sp29:
    ds_read_b32 v16, v17
    s_waitcnt lgkmcnt(0)
    v_readfirstlane_b32 s95, v16
    s_cmp_ge_u32 s95, 1
    s_cbranch_scc1 L_sd30
    s_sleep 4
    s_add_u32 s96, s96, 1
    s_cmp_lt_u32 s96, 2097152
    s_cbranch_scc1 L_sp29
L_sd30:
    v_mul_u32_u24 v9, 896, v14
    v_add_u32 v9, v9, v15
    s_lshl_b32 s80, s72, 7
    v_add_u32 v9, s80, v9
    s_lshl_b32 s82, s73, 2
    s_add_u32 s82, s82, s74
    s_mul_i32 s82, s82, 28672
    s_add_u32 m0, s81, 0
    s_add_u32 s83, s82, 0
    buffer_load_dwordx4 v9, s[44:47], s83 offen nt lds
    s_add_u32 m0, s81, 1024
    s_add_u32 s83, s82, 7168
    buffer_load_dwordx4 v9, s[44:47], s83 offen nt lds
    s_add_u32 m0, s81, 2048
    s_add_u32 s83, s82, 14336
    buffer_load_dwordx4 v9, s[44:47], s83 offen nt lds
    s_add_u32 m0, s81, 3072
    s_add_u32 s83, s82, 21504
    buffer_load_dwordx4 v9, s[44:47], s83 offen nt lds
    s_mul_i32 s80, s78, 112
    s_lshl_b32 s82, s72, 2
    s_add_u32 s80, s80, s82
    s_lshl_b32 s82, s79, 1
    s_add_u32 s80, s80, s82
    s_lshl_b32 s80, s80, 11
    s_lshl_b32 s82, s73, 6
    s_add_u32 s80, s80, s82
    s_add_u32 s80, s80, 1572864
    v_lshrrev_b32 v16, 2, v6
    v_mul_u32_u24 v56, 28, v16
    v_and_b32 v17, 1, v0
    v_add_u32 v56, v56, v17
    v_lshlrev_b32 v56, 11, v56
    v_lshl_add_u32 v56, v7, 4, v56
    v_add_u32 v56, s80, v56
    v_cmp_eq_u32 s[88:89], 1, v17
    v_mov_b32 v20, -1
    v_mov_b32 v21, -1
    v_mov_b32 v22, -1
    v_mov_b32 v23, -1
    s_mov_b32 exec_lo, 0x33333333
    s_mov_b32 exec_hi, 0x33333333
    buffer_store_dwordx4 v[20:23], v56, s[68:71], 0 offen sc1
    s_mov_b64 exec, -1
    s_lshl_b32 s80, s78, 8
    s_lshr_b32 s82, s73, 1
    s_lshl_b32 s82, s82, 2
    s_add_u32 s80, s80, s82
    v_and_b32 v17, 3, v0
    v_lshl_add_u32 v16, v16, 6, v17
    v_add_u32 v16, s80, v16
    s_and_b32 s80, s73, 1
    s_mul_i32 s80, s80, 384
    s_add_u32 s80, s80, 0
    v_mul_u32_u24 v10, 768, v16
    v_add_u32 v10, s80, v10
    v_lshl_add_u32 v11, v7, 4, v10
L_nowo:
    s_waitcnt vmcnt(0)
    v_mov_b32 v17, 155880
    v_mov_b32 v16, 1
    s_mov_b64 exec, 1
    s_waitcnt lgkmcnt(0)
    ds_add_u32 v17, v16
    s_mov_b64 exec, -1
    v_mov_b32 v17, 155880
    s_mov_b32 s96, 0
L_sp31:
    ds_read_b32 v16, v17
    s_waitcnt lgkmcnt(0)
    v_readfirstlane_b32 s95, v16
    s_cmp_ge_u32 s95, 4
    s_cbranch_scc1 L_sd32
    s_sleep 0
    s_add_u32 s96, s96, 1
    s_cmp_lt_u32 s96, 4194304
    s_cbranch_scc1 L_sp31
L_sd32:
    s_lshl_b32 s80, s79, 6
    s_add_u32 s80, s80, 131072
    v_add_u32 v8, s80, v63
    ds_read_b64_tr_b16 v[128:129], v8 offset:0
    ds_read_b64_tr_b16 v[130:131], v8 offset:512
    ds_read_b64_tr_b16 v[132:133], v8 offset:4096
    ds_read_b64_tr_b16 v[134:135], v8 offset:4608
    ds_read_b64_tr_b16 v[136:137], v8 offset:8192
    ds_read_b64_tr_b16 v[138:139], v8 offset:8704
    ds_read_b64_tr_b16 v[140:141], v8 offset:12288
    ds_read_b64_tr_b16 v[142:143], v8 offset:12800
    ds_read_b64_tr_b16 v[144:145], v8 offset:32
    ds_read_b64_tr_b16 v[146:147], v8 offset:544
    ds_read_b64_tr_b16 v[148:149], v8 offset:4128
    ds_read_b64_tr_b16 v[150:151], v8 offset:4640
    ds_read_b64_tr_b16 v[152:153], v8 offset:8224
    ds_read_b64_tr_b16 v[154:155], v8 offset:8736
    ds_read_b64_tr_b16 v[156:157], v8 offset:12320
    ds_read_b64_tr_b16 v[158:159], v8 offset:12832
    s_cmp_lg_u32 s74, 3
    s_cbranch_scc1 L_wgo
    s_lshl_b32 s80, s2, 3
    s_add_u32 s80, s80, 475136
    v_mov_b32 v16, s80
    v_mov_b32 v18, s4
    v_mov_b32 v19, s5
    s_mov_b64 exec, 1
    buffer_store_dwordx2 v[18:19], v16, s[68:71], 0 offen sc1
    s_mov_b64 exec, -1
    v_mov_b32 v17, 155876
    s_mov_b32 s96, 0
L_sp33:
    ds_read_b32 v16, v17
    s_waitcnt lgkmcnt(0)
    v_readfirstlane_b32 s95, v16
    s_cmp_ge_u32 s95, 1
    s_cbranch_scc1 L_sd34
    s_sleep 16
    s_add_u32 s96, s96, 1
    s_cmp_lt_u32 s96, 2097152
    s_cbranch_scc1 L_sp33
L_sd34:
    v_lshlrev_b32 v20, 4, v0
    v_add_u32 v20, 475136, v20
    s_mov_b32 s96, 0
L_gp35:
    buffer_load_dwordx4 v[24:27], v20, s[68:71], 0 offen sc1
    buffer_load_dwordx4 v[28:31], v20, s[68:71], 0 offen offset:1024 sc1
    s_waitcnt vmcnt(0)
    v_xor_b32 v24, s4, v24
    v_xor_b32 v25, s5, v25
    v_xor_b32 v26, s4, v26
    v_xor_b32 v27, s5, v27
    v_xor_b32 v28, s4, v28
    v_xor_b32 v29, s5, v29
    v_xor_b32 v30, s4, v30
    v_xor_b32 v31, s5, v31
    v_or_b32 v16, v24, v25
    v_or3_b32 v16, v16, v26, v27
    v_or3_b32 v16, v16, v28, v29
    v_or3_b32 v16, v16, v30, v31
    v_cmp_ne_u32 vcc, 0, v16
    s_cbranch_vccz L_gd36
    s_sleep 32
    s_add_u32 s96, s96, 1
    s_cmp_lt_u32 s96, 131072
    s_cbranch_scc1 L_gp35
L_gd36:
    v_mov_b32 v17, 155844
    v_mov_b32 v16, 1
    ds_write_b32 v17, v16
    s_cmp_lg_u32 s2, 0
    s_cbranch_scc1 L_nb
    v_mov_b32 v16, 491520
    s_mov_b64 exec, 1
    buffer_store_dwordx2 v[18:19], v16, s[68:71], 0 offen sc1
    s_mov_b64 exec, -1
L_nb:
    s_cmp_eq_u32 s72, 7
    s_cbranch_scc1 L_end
    s_lshl_b32 s82, s72, 2
    s_and_b32 s83, s73, 3
    s_add_u32 s82, s82, s83
    s_lshr_b32 s83, s73, 2
    s_mul_i32 s83, s83, 28
    s_add_u32 s82, s82, s83
    s_lshl_b32 s83, s82, 5
    v_and_b32 v16, 3, v0
    v_lshl_add_u32 v104, v16, 3, s83
    s_lshl_b32 s83, s82, 11
    s_add_u32 s83, s83, 1572864
    v_lshl_add_u32 v105, v0, 4, s83
    buffer_load_dwordx2 v[102:103], v104, s[36:39], 0 offen
    v_lshrrev_b32 v16, 2, v0
    v_mul_u32_u24 v16, 14336, v16
    v_lshl_add_u32 v16, v104, 1, v16
    s_mov_b32 s82, 1048576
    s_mov_b32 s83, 1277952
    v_mov_b32 v28, 0
    v_mov_b32 v29, 0
    v_mov_b32 v30, 0
    v_mov_b32 v31, 0
    buffer_load_dwordx4 v[24:27], v16, s[68:71], s82 offen sc1
    s_mov_b32 exec_hi, 0xffff
    buffer_load_dwordx4 v[28:31], v16, s[68:71], s83 offen sc1
    s_mov_b64 exec, -1
    s_waitcnt vmcnt(0)
    v_add_f32 v24, v24, v28
    v_add_f32 v25, v25, v29
    v_add_f32 v26, v26, v30
    v_add_f32 v27, v27, v31
    v_add_f32_dpp v24, v24, v24 row_ror:4 row_mask:0xf bank_mask:0xf
    v_add_f32_dpp v25, v25, v25 row_ror:4 row_mask:0xf bank_mask:0xf
    v_add_f32_dpp v26, v26, v26 row_ror:4 row_mask:0xf bank_mask:0xf
    v_add_f32_dpp v27, v27, v27 row_ror:4 row_mask:0xf bank_mask:0xf
    v_add_f32_dpp v24, v24, v24 row_ror:8 row_mask:0xf bank_mask:0xf
    v_add_f32_dpp v25, v25, v25 row_ror:8 row_mask:0xf bank_mask:0xf
    v_add_f32_dpp v26, v26, v26 row_ror:8 row_mask:0xf bank_mask:0xf
    v_add_f32_dpp v27, v27, v27 row_ror:8 row_mask:0xf bank_mask:0xf
    v_mov_b32 v28, v24
    v_mov_b32 v29, v25
    v_mov_b32 v30, v26
    v_mov_b32 v31, v27
    s_nop 1
    v_permlane32_swap_b32 v24, v28
    v_permlane32_swap_b32 v25, v29
    v_permlane32_swap_b32 v26, v30
    v_permlane32_swap_b32 v27, v31
    s_nop 1
    v_add_f32 v24, v24, v28
    v_add_f32 v25, v25, v29
    v_add_f32 v26, v26, v30
    v_add_f32 v27, v27, v31
    v_mov_b32 v28, v24
    v_mov_b32 v29, v25
    v_mov_b32 v30, v26
    v_mov_b32 v31, v27
    s_nop 1
    v_permlane16_swap_b32 v24, v28
    v_permlane16_swap_b32 v25, v29
    v_permlane16_swap_b32 v26, v30
    v_permlane16_swap_b32 v27, v31
    s_nop 1
    v_add_f32 v24, v24, v28
    v_add_f32 v25, v25, v29
    v_add_f32 v26, v26, v30
    v_add_f32 v27, v27, v31
    v_cvt_pk_bf16_f32 v24, v24, v24
    v_and_b32 v24, 0xffff0000, v24
    v_mul_f32 v28, 0xbfb8aa3b, v24
    v_exp_f32 v28, v28
    s_nop 0
    v_add_f32 v28, 1.0, v28
    v_rcp_f32 v28, v28
    s_nop 0
    v_mul_f32 v28, v24, v28
    v_cvt_pk_bf16_f32 v96, v28, v28
    v_and_b32 v96, 0xffff0000, v96
    v_cvt_pk_bf16_f32 v25, v25, v25
    v_and_b32 v25, 0xffff0000, v25
    v_mul_f32 v28, 0xbfb8aa3b, v25
    v_exp_f32 v28, v28
    s_nop 0
    v_add_f32 v28, 1.0, v28
    v_rcp_f32 v28, v28
    s_nop 0
    v_mul_f32 v28, v25, v28
    v_cvt_pk_bf16_f32 v97, v28, v28
    v_and_b32 v97, 0xffff0000, v97
    v_cvt_pk_bf16_f32 v26, v26, v26
    v_and_b32 v26, 0xffff0000, v26
    v_mul_f32 v28, 0xbfb8aa3b, v26
    v_exp_f32 v28, v28
    s_nop 0
    v_add_f32 v28, 1.0, v28
    v_rcp_f32 v28, v28
    s_nop 0
    v_mul_f32 v28, v26, v28
    v_cvt_pk_bf16_f32 v98, v28, v28
    v_and_b32 v98, 0xffff0000, v98
    v_cvt_pk_bf16_f32 v27, v27, v27
    v_and_b32 v27, 0xffff0000, v27
    v_mul_f32 v28, 0xbfb8aa3b, v27
    v_exp_f32 v28, v28
    s_nop 0
    v_add_f32 v28, 1.0, v28
    v_rcp_f32 v28, v28
    s_nop 0
    v_mul_f32 v28, v27, v28
    v_cvt_pk_bf16_f32 v99, v28, v28
    v_and_b32 v99, 0xffff0000, v99
    v_lshlrev_b32 v100, 16, v102
    v_and_b32 v101, 0xffff0000, v102
    v_lshlrev_b32 v102, 16, v103
    v_and_b32 v103, 0xffff0000, v103
L_wgo:
    s_cmp_eq_u32 s72, 7
    s_cbranch_scc1 L_end
    s_mov_b32 s84, 0
L_real:
    v_mov_b32 v17, 155852
    s_mov_b32 s96, 0
L_sp37:
    ds_read_b32 v16, v17
    s_waitcnt lgkmcnt(0)
    v_readfirstlane_b32 s95, v16
    s_cmp_ge_u32 s95, 4
    s_cbranch_scc1 L_sd38
    s_sleep 1
    s_add_u32 s96, s96, 1
    s_cmp_lt_u32 s96, 2097152
    s_cbranch_scc1 L_sp37
L_sd38:
L_tail:
    s_mov_b32 s96, s84
    s_mov_b64 s[90:91], 0
    s_mov_b32 s94, 0
L_pay:
    buffer_load_dwordx2 v[60:61], v10, s[68:71], 0 offen offset:256 sc1
    buffer_load_dwordx4 v[64:67], v11, s[68:71], 0 offen offset:0 sc1
    buffer_load_dwordx4 v[68:71], v11, s[68:71], 0 offen offset:64 sc1
    buffer_load_dwordx4 v[72:75], v11, s[68:71], 0 offen offset:128 sc1
    buffer_load_dwordx4 v[76:79], v11, s[68:71], 0 offen offset:192 sc1
    s_waitcnt vmcnt(0)
    v_max_u32 v18, v60, v61
    v_max3_u32 v18, v18, v64, v65
    v_max3_u32 v18, v18, v66, v67
    v_max3_u32 v18, v18, v68, v69
    v_max3_u32 v18, v18, v70, v71
    v_max3_u32 v18, v18, v72, v73
    v_max3_u32 v18, v18, v74, v75
    v_max3_u32 v18, v18, v76, v77
    v_max3_u32 v18, v18, v78, v79
    v_cmp_eq_u32 vcc, -1, v18
    s_andn2_b64 s[90:91], s[90:91], exec
    s_or_b64 s[90:91], s[90:91], vcc
    s_cbranch_scc0 L_payok
    s_add_u32 s96, s96, 1
    s_cmp_ge_u32 s96, 0x40000
    s_cbranch_scc1 L_payok
    s_mov_b64 exec, s[90:91]
    s_cbranch_vccz L_pay
    s_ff1_i32_b64 s94, vcc
    s_and_b32 s94, s94, 15
    s_mov_b32 s92, 0x10001
    s_mov_b32 s93, 0x10001
    s_lshl_b64 s[92:93], s[92:93], s94
    s_and_b64 exec, s[92:93], vcc
    s_sleep 0
    s_branch L_pay
L_payok:
    s_mov_b64 exec, -1
    v_mfma_f32_16x16x32_bf16 v[32:35], v[128:131], v[64:67], 0
    v_max_f32_dpp v16, v60, v60 quad_perm:[1,0,3,2] row_mask:0xf bank_mask:0xf
    s_nop 0
    v_mfma_f32_16x16x32_bf16 v[36:39], v[144:147], v[64:67], 0
    v_max_f32_dpp v16, v16, v16 quad_perm:[2,3,0,1] row_mask:0xf bank_mask:0xf
    v_sub_f32 v16, v60, v16
    v_mfma_f32_16x16x32_bf16 v[32:35], v[132:135], v[68:71], v[32:35]
    v_exp_f32 v16, v16
    v_mfma_f32_16x16x32_bf16 v[36:39], v[148:151], v[68:71], v[36:39]
    v_mul_f32 v16, v16, v61
    s_nop 0
    v_mfma_f32_16x16x32_bf16 v[32:35], v[136:139], v[72:75], v[32:35]
    v_add_f32_dpp v17, v16, v16 quad_perm:[1,0,3,2] row_mask:0xf bank_mask:0xf
    s_nop 0
    v_mfma_f32_16x16x32_bf16 v[36:39], v[152:155], v[72:75], v[36:39]
    v_add_f32_dpp v17, v17, v17 quad_perm:[2,3,0,1] row_mask:0xf bank_mask:0xf
    v_mfma_f32_16x16x32_bf16 v[32:35], v[140:143], v[76:79], v[32:35]
    v_rcp_f32 v17, v17
    v_mfma_f32_16x16x32_bf16 v[36:39], v[156:159], v[76:79], v[36:39]
    v_mul_f32 v16, v16, v17
    s_nop 4
    v_mul_f32 v32, v32, v16
    v_mul_f32 v33, v33, v16
    v_mul_f32 v34, v34, v16
    v_mul_f32 v35, v35, v16
    v_mul_f32 v36, v36, v16
    v_mul_f32 v37, v37, v16
    v_mul_f32 v38, v38, v16
    v_mul_f32 v39, v39, v16
    v_add_f32_dpp v32, v32, v32 quad_perm:[1,0,3,2] row_mask:0xf bank_mask:0xf
    v_add_f32_dpp v33, v33, v33 quad_perm:[1,0,3,2] row_mask:0xf bank_mask:0xf
    v_add_f32_dpp v34, v34, v34 quad_perm:[1,0,3,2] row_mask:0xf bank_mask:0xf
    v_add_f32_dpp v35, v35, v35 quad_perm:[1,0,3,2] row_mask:0xf bank_mask:0xf
    v_add_f32_dpp v36, v36, v36 quad_perm:[1,0,3,2] row_mask:0xf bank_mask:0xf
    v_add_f32_dpp v37, v37, v37 quad_perm:[1,0,3,2] row_mask:0xf bank_mask:0xf
    v_add_f32_dpp v38, v38, v38 quad_perm:[1,0,3,2] row_mask:0xf bank_mask:0xf
    v_add_f32_dpp v39, v39, v39 quad_perm:[1,0,3,2] row_mask:0xf bank_mask:0xf
    v_add_f32_dpp v32, v32, v32 quad_perm:[2,3,0,1] row_mask:0xf bank_mask:0xf
    v_add_f32_dpp v33, v33, v33 quad_perm:[2,3,0,1] row_mask:0xf bank_mask:0xf
    v_add_f32_dpp v34, v34, v34 quad_perm:[2,3,0,1] row_mask:0xf bank_mask:0xf
    v_add_f32_dpp v35, v35, v35 quad_perm:[2,3,0,1] row_mask:0xf bank_mask:0xf
    v_add_f32_dpp v36, v36, v36 quad_perm:[2,3,0,1] row_mask:0xf bank_mask:0xf
    v_add_f32_dpp v37, v37, v37 quad_perm:[2,3,0,1] row_mask:0xf bank_mask:0xf
    v_add_f32_dpp v38, v38, v38 quad_perm:[2,3,0,1] row_mask:0xf bank_mask:0xf
    v_add_f32_dpp v39, v39, v39 quad_perm:[2,3,0,1] row_mask:0xf bank_mask:0xf
    v_cndmask_b32 v32, v32, v36, s[88:89]
    v_cndmask_b32 v33, v33, v37, s[88:89]
    v_cndmask_b32 v34, v34, v38, s[88:89]
    v_cndmask_b32 v35, v35, v39, s[88:89]
    v_min_u32 v32, -2, v32
    v_min_u32 v33, -2, v33
    v_min_u32 v34, -2, v34
    v_min_u32 v35, -2, v35
    s_cmp_lg_u32 s84, 0
    s_cbranch_scc1 L_t1
    s_mov_b32 exec_lo, 0x33333333
    s_mov_b32 exec_hi, 0x33333333
    buffer_store_dwordx4 v[32:35], v56, s[68:71], 0 offen sc1
    s_mov_b64 exec, -1
    s_cmp_lg_u32 s74, 3
    s_cbranch_scc1 L_end
L_t1:
    s_mov_b32 s96, s84
L_y:
    buffer_load_dwordx4 v[24:27], v105, s[68:71], 0 offen sc1
    buffer_load_dwordx4 v[28:31], v105, s[68:71], 0 offen offset:1024 sc1
    s_waitcnt vmcnt(0)
    v_max_u32 v18, v24, v25
    v_max3_u32 v18, v18, v26, v27
    v_max3_u32 v18, v18, v28, v29
    v_max3_u32 v18, v18, v30, v31
    v_cmp_eq_u32 vcc, -1, v18
    s_cbranch_vccz L_yok
    s_mov_b64 exec, vcc
    s_sleep 0
    s_add_u32 s96, s96, 1
    s_cmp_lt_u32 s96, 0x20000
    s_cbranch_scc1 L_y
L_yok:
    s_mov_b64 exec, -1
    v_add_f32 v24, v24, v28
    v_add_f32 v25, v25, v29
    v_add_f32 v26, v26, v30
    v_add_f32 v27, v27, v31
    v_add_f32_dpp v24, v24, v24 row_ror:4 row_mask:0xf bank_mask:0xf
    v_add_f32_dpp v25, v25, v25 row_ror:4 row_mask:0xf bank_mask:0xf
    v_add_f32_dpp v26, v26, v26 row_ror:4 row_mask:0xf bank_mask:0xf
    v_add_f32_dpp v27, v27, v27 row_ror:4 row_mask:0xf bank_mask:0xf
    v_add_f32_dpp v24, v24, v24 row_ror:8 row_mask:0xf bank_mask:0xf
    v_add_f32_dpp v25, v25, v25 row_ror:8 row_mask:0xf bank_mask:0xf
    v_add_f32_dpp v26, v26, v26 row_ror:8 row_mask:0xf bank_mask:0xf
    v_add_f32_dpp v27, v27, v27 row_ror:8 row_mask:0xf bank_mask:0xf
    v_mov_b32 v28, v24
    v_mov_b32 v29, v25
    v_mov_b32 v30, v26
    v_mov_b32 v31, v27
    s_nop 1
    v_permlane32_swap_b32 v24, v28
    v_permlane32_swap_b32 v25, v29
    v_permlane32_swap_b32 v26, v30
    v_permlane32_swap_b32 v27, v31
    s_nop 1
    v_add_f32 v24, v24, v28
    v_add_f32 v25, v25, v29
    v_add_f32 v26, v26, v30
    v_add_f32 v27, v27, v31
    v_mov_b32 v28, v24
    v_mov_b32 v29, v25
    v_mov_b32 v30, v26
    v_mov_b32 v31, v27
    s_nop 1
    v_permlane16_swap_b32 v24, v28
    v_permlane16_swap_b32 v25, v29
    v_permlane16_swap_b32 v26, v30
    v_permlane16_swap_b32 v27, v31
    s_nop 1
    v_add_f32 v24, v24, v28
    v_add_f32 v25, v25, v29
    v_add_f32 v26, v26, v30
    v_add_f32 v27, v27, v31
    v_cvt_pk_bf16_f32 v24, v24, v24
    v_and_b32 v24, 0xffff0000, v24
    v_cvt_pk_bf16_f32 v25, v25, v25
    v_and_b32 v25, 0xffff0000, v25
    v_cvt_pk_bf16_f32 v26, v26, v26
    v_and_b32 v26, 0xffff0000, v26
    v_cvt_pk_bf16_f32 v27, v27, v27
    v_and_b32 v27, 0xffff0000, v27
    v_mul_f32 v24, v24, v96
    v_mul_f32 v25, v25, v97
    v_mul_f32 v26, v26, v98
    v_mul_f32 v27, v27, v99
    v_cvt_pk_bf16_f32 v24, v24, v24
    v_and_b32 v24, 0xffff0000, v24
    v_cvt_pk_bf16_f32 v25, v25, v25
    v_and_b32 v25, 0xffff0000, v25
    v_cvt_pk_bf16_f32 v26, v26, v26
    v_and_b32 v26, 0xffff0000, v26
    v_cvt_pk_bf16_f32 v27, v27, v27
    v_and_b32 v27, 0xffff0000, v27
    v_add_f32 v24, v24, v100
    v_add_f32 v25, v25, v101
    v_add_f32 v26, v26, v102
    v_add_f32 v27, v27, v103
    v_cvt_pk_bf16_f32 v24, v24, v25
    v_cvt_pk_bf16_f32 v25, v26, v27
    s_cmp_lg_u32 s84, 0
    s_mov_b32 s84, 0
    s_cbranch_scc1 L_real
    s_mov_b64 exec, 15
    buffer_store_dwordx2 v[24:25], v104, s[60:63], 0 offen sc1
    s_mov_b64 exec, -1
L_end:
    s_endpgm
.section .rodata,"a"
.p2align 6
.amdhsa_kernel recurrent_scan__gqa_block_cached__glu_gated_bilinear__decode_kernel
  .amdhsa_next_free_vgpr 256
  .amdhsa_next_free_sgpr 102
  .amdhsa_accum_offset 256
  .amdhsa_group_segment_fixed_size 0
  .amdhsa_kernarg_size 96
  .amdhsa_user_sgpr_count 2
  .amdhsa_user_sgpr_kernarg_segment_ptr 1
  .amdhsa_system_sgpr_workgroup_id_x 1
.end_amdhsa_kernel
```
